```python
import torch

def _softmax(x, axis=-1):
    return torch.softmax(x, dim=axis)
def _gelu(x):
    return torch.nn.functional.gelu(x, approximate="tanh")
def _silu(x):
    return torch.nn.functional.silu(x)
def _sigmoid(x):
    return torch.sigmoid(x)
def _layernorm(x, axis=-1, eps=1e-5):
    m = x.mean(dim=axis, keepdim=True)
    v = x.var(dim=axis, keepdim=True, unbiased=False)
    return (x - m) / torch.sqrt(v + eps)
def _scatter_add(tgt, idx, src, axis=0):
    return tgt.clone().index_add_(axis, idx, src)
def _segment_sum(src, seg, n):
    out = torch.zeros((n,) + src.shape[1:], dtype=src.dtype)
    return out.index_add_(0, seg, src)
def _pad(x, pw):
    flat = tuple(v for pair in reversed(pw) for v in pair)
    return torch.nn.functional.pad(x, flat)

kernel_name = 'gated_mix__sliding_block__mixer_token_mlp__prompt'

def setup_inputs():

    _w = (lambda a: (lambda t: t.to(torch.bfloat16) if t.is_floating_point() else t)(torch.as_tensor(a)))
    def _A_setup():
        B, S, D = 1, 2048, 512
        return {
            "x": _w((lambda *s: torch.randn(*s, dtype=torch.bfloat16) * 0.05)(B, S, D)),
            "wqkv": _w((lambda *s: torch.randn(*s, dtype=torch.bfloat16) * 0.8)(D, 3 * D)),
            "wo": _w((lambda *s: torch.randn(*s, dtype=torch.bfloat16) * 0.05)(D, D)),
        }
    _A_in = _A_setup()

    def _B_setup():
        B, S, D, F = 1, 2048, 512, 1376
        return {
            "x": _w((lambda *s: torch.randn(*s, dtype=torch.bfloat16) * 0.05)(B, S, D)),
            "w1": _w((lambda *s: torch.randn(*s, dtype=torch.bfloat16) * 3.2)(S, F) * (S ** -0.5)),
            "b1": _w((lambda *s: torch.randn(*s, dtype=torch.bfloat16) * 3.2)(F) * 0.02),
            "w2": _w((lambda *s: torch.randn(*s, dtype=torch.bfloat16) * 0.1)(F, S) * (F ** -0.5)),
            "b2": _w((lambda *s: torch.randn(*s, dtype=torch.bfloat16) * 0.1)(S) * 0.02),
        }
    _B_in = _B_setup()

    return {
        "A_x": _A_in["x"],
        "A_wqkv": _A_in["wqkv"],
        "A_wo": _A_in["wo"],
        "B_x": _B_in["x"],
        "B_w1": _B_in["w1"],
        "B_b1": _B_in["b1"],
        "B_w2": _B_in["w2"],
        "B_b2": _B_in["b2"],
        "gate_w": _w((lambda *s: torch.randn(*s, dtype=torch.bfloat16) * 0.05)(512) * 16.0),
    }

def reference(A_x, A_wqkv, A_wo, B_x, B_w1, B_b1, B_w2, B_b2, gate_w):
    def _A_ref(x, wqkv, wo):
        B, S, D = x.shape
        H = 32; Dh = D // H; W = 256
        qkv = (lambda x, *d: x.permute(*d))((x @ wqkv).reshape(B, S, 3, H, Dh), 2, 0, 3, 1, 4)
        q, k, v = qkv[0], qkv[1], qkv[2]
        scores = torch.einsum("bhqd,bhkd->bhqk", q, k) * (Dh ** -0.5)
        idx = torch.arange(S)
        mask = (idx[:, None] - idx[None, :] >= 0) & (idx[:, None] - idx[None, :] < W)
        scores = torch.where(mask[None, None], scores, -1e9)
        p = _softmax(scores, axis=-1)
        o = torch.einsum("bhqk,bhkd->bhqd", p, v)
        return (lambda x, *d: x.permute(*d))(o, 0, 2, 1, 3).reshape(B, S, D) @ wo

    def _B_ref(x, w1, b1, w2, b2):
        B, S, D = x.shape
        h = _layernorm(x, axis=-1)
        u = torch.einsum("bsd,sf->bdf", h, w1) + b1
        u = _gelu(u)
        y = torch.einsum("bdf,fs->bds", u, w2) + b2
        return (lambda x, *d: x.permute(*d))(y, 0, 2, 1)

    x = A_x
    g = _sigmoid((x * gate_w).sum(-1, keepdims=True))
    a = _A_ref(x, A_wqkv, A_wo)
    b = _B_ref(x, B_w1, B_b1, B_w2, B_b2)
    return g * a + (1 - g) * b
```

```asm
; @launch kernel=k1_kernel grid=(256,1,1) block=(512,1,1) lds=163840
; @launch kernel=k2_kernel grid=(256,1,1) block=(512,1,1) lds=132096
; @launch kernel=k3_kernel grid=(256,1,1) block=(256,1,1) lds=135168
.amdgcn_target "amdgcn-amd-amdhsa--gfx950"
.text
.globl k1_kernel
.p2align 8
.type k1_kernel,@function
k1_kernel:
    s_cmp_ge_u32 s2, 256
    s_cbranch_scc1 K1_end
    s_load_dwordx4 s[4:7], s[0:1], 0
    s_load_dwordx2 s[8:9], s[0:1], 32
    s_load_dwordx2 s[10:11], s[0:1], 64
    s_load_dwordx2 s[12:13], s[0:1], 88
    v_and_b32 v1, 63, v0
    v_lshrrev_b32 v2, 6, v0
    s_and_b32 s34, s2, 7
    v_readfirstlane_b32 s33, v2
    s_lshr_b32 s35, s2, 3
    s_cmp_ge_u32 s35, 24
    s_cbranch_scc1 K1_aux
    s_mul_i32 s36, s35, 43
    s_lshr_b32 s36, s36, 8
    s_mul_i32 s37, s36, 6
    s_sub_u32 s37, s35, s37
    s_lshr_b32 s38, s34, 1
    s_lshl_b32 s38, s38, 2
    s_add_u32 s38, s38, s36
    s_lshr_b32 s39, s37, 1
    s_and_b32 s40, s34, 1
    s_lshl_b32 s40, s40, 1
    s_and_b32 s41, s37, 1
    s_add_u32 s40, s40, s41
    s_cmp_lt_u32 s33, 4
    s_cbranch_scc1 K1_cons
    s_sub_u32 s33, s33, 4
    s_lshl_b32 s41, s39, 9
    s_lshl_b32 s42, s40, 7
    s_add_u32 s41, s41, s42
    s_and_b32 s42, s33, 1
    s_lshl_b32 s42, s42, 2
    v_lshrrev_b32 v3, 4, v1
    v_add_u32 v4, s42, v3
    v_and_b32 v5, 7, v1
    v_xor_b32 v4, v4, v5
    v_lshrrev_b32 v5, 3, v1
    v_lshlrev_b32 v5, 10, v5
    v_lshl_add_u32 v10, v4, 4, v5
    v_lshlrev_b32 v4, 2, v3
    v_and_b32 v5, 15, v1
    v_xor_b32 v4, v4, v5
    v_mul_u32_u24 v5, 3072, v3
    v_lshl_add_u32 v11, v4, 4, v5
    s_lshl_b32 s46, s38, 7
    s_lshl_b32 s44, s33, 3
    s_add_u32 s46, s46, s44
    s_lshl_b32 s46, s46, 10
    s_mul_i32 s47, s33, 12288
    s_lshl_b32 s45, s41, 1
    s_add_u32 s47, s47, s45
    s_lshl_b32 s48, s33, 10
    s_lshl_b32 s57, s36, 1
    s_add_u32 s57, s57, s37
    s_and_b32 s57, s57, 7
    s_waitcnt lgkmcnt(0)
    s_mov_b32 s16, s4
    s_and_b32 s17, s5, 0xffff
    s_mov_b32 s18, 0x200000
    s_mov_b32 s19, 0x00020000
    s_mov_b32 s20, s6
    s_and_b32 s21, s7, 0xffff
    s_mov_b32 s22, 0x180000
    s_mov_b32 s23, 0x00020000
    s_mov_b32 s49, 0
    s_mov_b32 s60, s48
K1_ld:
    s_lshl_b32 s58, s57, 7
    s_add_u32 s58, s58, s46
    s_mul_i32 s59, s57, 196608
    s_add_u32 s59, s59, s47
    s_add_u32 m0, s48, 0
    s_add_u32 s50, s58, 0
    buffer_load_dwordx4 v10, s[16:19], s50 offen lds
    s_add_u32 m0, s48, 81920
    s_add_u32 s50, s59, 0
    buffer_load_dwordx4 v11, s[20:23], s50 offen lds
    s_add_u32 m0, s48, 4096
    s_add_u32 s50, s58, 32768
    buffer_load_dwordx4 v10, s[16:19], s50 offen lds
    s_add_u32 m0, s48, 86016
    s_add_u32 s50, s59, 49152
    buffer_load_dwordx4 v11, s[20:23], s50 offen lds
    s_add_u32 m0, s48, 8192
    s_add_u32 s50, s58, 65536
    buffer_load_dwordx4 v10, s[16:19], s50 offen lds
    s_add_u32 m0, s48, 90112
    s_add_u32 s50, s59, 98304
    buffer_load_dwordx4 v11, s[20:23], s50 offen lds
    s_add_u32 m0, s48, 12288
    s_add_u32 s50, s58, 98304
    buffer_load_dwordx4 v10, s[16:19], s50 offen lds
    s_add_u32 m0, s48, 94208
    s_add_u32 s50, s59, 147456
    buffer_load_dwordx4 v11, s[20:23], s50 offen lds
    s_add_u32 s57, s57, 1
    s_and_b32 s57, s57, 7
    s_add_u32 s48, s48, 16384
    s_cmp_ge_u32 s48, 81920
    s_cselect_b32 s48, s60, s48
    s_add_u32 s49, s49, 1
    s_cmp_lt_u32 s49, 3
    s_cbranch_scc1 K1_ld
    s_cmp_eq_u32 s49, 4
    s_cbranch_scc1 K1_ld
    s_cmp_eq_u32 s49, 5
    s_cbranch_scc0 K1_ld2
    s_waitcnt vmcnt(24)
    s_barrier
K1_ld2:
    s_waitcnt vmcnt(16)
    s_barrier
    s_cmp_lt_u32 s49, 8
    s_cbranch_scc1 K1_ld
    s_waitcnt vmcnt(8)
    s_barrier
    s_waitcnt vmcnt(0)
    s_barrier
    s_endpgm
K1_cons:
    s_cmp_eq_u32 s33, 3
    s_cbranch_scc0 K1_ncp
    s_getpc_b64 s[64:65]
CP_k1n:
    s_add_u32 s64, s64, k1_kernel-CP_k1n
    s_addc_u32 s65, s65, -1
    v_lshlrev_b32 v28, 7, v1
    v_min_u32 v30, CODE_END-k1_kernel-4, v28
    global_load_dword v29, v30, s[64:65]
    v_add_u32 v28, 8192, v28
    v_min_u32 v30, CODE_END-k1_kernel-4, v28
    global_load_dword v29, v30, s[64:65]
    v_add_u32 v28, 8192, v28
    v_min_u32 v30, CODE_END-k1_kernel-4, v28
    global_load_dword v29, v30, s[64:65]
K1_ncp:
    s_lshr_b32 s51, s33, 1
    s_and_b32 s52, s33, 1
    v_bfe_u32 v3, v1, 1, 3
    v_lshrrev_b32 v4, 5, v1
    v_xor_b32 v5, v3, v4
    v_and_b32 v6, 31, v1
    s_lshl_b32 s53, s51, 13
    v_lshl_add_u32 v6, v6, 7, s53
    v_xor_b32 v7, 0, v5
    v_lshl_add_u32 v12, v7, 4, v6
    v_xor_b32 v7, 2, v5
    v_lshl_add_u32 v13, v7, 4, v6
    v_xor_b32 v7, 4, v5
    v_lshl_add_u32 v14, v7, 4, v6
    v_xor_b32 v7, 6, v5
    v_lshl_add_u32 v15, v7, 4, v6
    v_bfe_u32 v3, v1, 2, 2
    v_lshl_add_u32 v5, v4, 3, v3
    v_lshlrev_b32 v5, 8, v5
    s_lshl_b32 s53, s52, 1
    v_xor_b32 v6, s53, v3
    v_lshl_add_u32 v5, v6, 6, v5
    v_bfe_u32 v6, v1, 4, 1
    v_lshl_add_u32 v5, v6, 5, v5
    v_and_b32 v6, 3, v1
    v_lshl_add_u32 v5, v6, 3, v5
    v_add_u32 v16, 81920, v5
    v_xor_b32 v17, 64, v16
    v_mov_b32 v20, v12
    v_mov_b32 v21, v13
    v_mov_b32 v22, v14
    v_mov_b32 v23, v15
    v_mov_b32 v24, v16
    v_mov_b32 v25, v17
    v_mov_b64 v[96:97], 0
    v_mov_b64 v[98:99], 0
    v_mov_b64 v[100:101], 0
    v_mov_b64 v[102:103], 0
    v_mov_b64 v[104:105], 0
    v_mov_b64 v[106:107], 0
    v_mov_b64 v[108:109], 0
    v_mov_b64 v[110:111], 0
    v_mov_b64 v[112:113], 0
    v_mov_b64 v[114:115], 0
    v_mov_b64 v[116:117], 0
    v_mov_b64 v[118:119], 0
    v_mov_b64 v[120:121], 0
    v_mov_b64 v[122:123], 0
    v_mov_b64 v[124:125], 0
    v_mov_b64 v[126:127], 0
    v_mov_b64 v[128:129], 0
    v_mov_b64 v[130:131], 0
    v_mov_b64 v[132:133], 0
    v_mov_b64 v[134:135], 0
    v_mov_b64 v[136:137], 0
    v_mov_b64 v[138:139], 0
    v_mov_b64 v[140:141], 0
    v_mov_b64 v[142:143], 0
    v_mov_b64 v[144:145], 0
    v_mov_b64 v[146:147], 0
    v_mov_b64 v[148:149], 0
    v_mov_b64 v[150:151], 0
    v_mov_b64 v[152:153], 0
    v_mov_b64 v[154:155], 0
    v_mov_b64 v[156:157], 0
    v_mov_b64 v[158:159], 0
    s_lshl_b32 s53, s40, 3
    s_lshl_b32 s54, s52, 2
    s_add_u32 s53, s53, s54
    s_lshl_b32 s53, s53, 16
    s_lshl_b32 s54, s38, 2
    s_lshl_b32 s55, s51, 1
    s_add_u32 s54, s54, s55
    s_lshl_b32 s54, s54, 10
    s_add_u32 s53, s53, s54
    s_lshl_b32 s54, s39, 21
    s_add_u32 s53, s53, s54
    s_cmp_eq_u32 s39, 0
    s_cselect_b32 s56, 0x3eb8aa3b, 1.0
    s_mov_b32 s49, 0
    s_mov_b32 s54, 0
    s_waitcnt lgkmcnt(0)
    s_mov_b32 s24, s12
    s_and_b32 s25, s13, 0xffff
    s_mov_b32 s26, 0x1300000
    s_mov_b32 s27, 0x00020000
    s_barrier
    ds_read_b128 v[32:35], v20 offset:0
    ds_read_b128 v[36:39], v20 offset:4096
    ds_read_b64_tr_b16 v[40:41], v24 offset:0
    ds_read_b64_tr_b16 v[42:43], v24 offset:1024
    ds_read_b64_tr_b16 v[44:45], v25 offset:0
    ds_read_b64_tr_b16 v[46:47], v25 offset:1024
    ds_read_b128 v[48:51], v21 offset:0
    ds_read_b128 v[52:55], v21 offset:4096
    ds_read_b64_tr_b16 v[56:57], v24 offset:4096
    ds_read_b64_tr_b16 v[58:59], v24 offset:5120
    ds_read_b64_tr_b16 v[60:61], v25 offset:4096
    ds_read_b64_tr_b16 v[62:63], v25 offset:5120
    s_cmp_eq_u32 s39, 2
    s_cbranch_scc1 K1_loop_v
K1_loop_qk:
    s_waitcnt lgkmcnt(6)
    v_mfma_f32_32x32x16_bf16 v[96:111], v[40:43], v[32:35], v[96:111]
    ds_read_b128 v[64:67], v22 offset:0
    ds_read_b128 v[68:71], v22 offset:4096
    v_mfma_f32_32x32x16_bf16 v[112:127], v[40:43], v[36:39], v[112:127]
    ds_read_b64_tr_b16 v[72:73], v24 offset:8192
    ds_read_b64_tr_b16 v[74:75], v24 offset:9216
    v_mfma_f32_32x32x16_bf16 v[128:143], v[44:47], v[32:35], v[128:143]
    ds_read_b64_tr_b16 v[76:77], v25 offset:8192
    ds_read_b64_tr_b16 v[78:79], v25 offset:9216
    v_mfma_f32_32x32x16_bf16 v[144:159], v[44:47], v[36:39], v[144:159]
    s_waitcnt lgkmcnt(6)
    v_mfma_f32_32x32x16_bf16 v[96:111], v[56:59], v[48:51], v[96:111]
    ds_read_b128 v[80:83], v23 offset:0
    ds_read_b128 v[84:87], v23 offset:4096
    v_mfma_f32_32x32x16_bf16 v[112:127], v[56:59], v[52:55], v[112:127]
    ds_read_b64_tr_b16 v[88:89], v24 offset:12288
    ds_read_b64_tr_b16 v[90:91], v24 offset:13312
    v_mfma_f32_32x32x16_bf16 v[128:143], v[60:63], v[48:51], v[128:143]
    ds_read_b64_tr_b16 v[92:93], v25 offset:12288
    ds_read_b64_tr_b16 v[94:95], v25 offset:13312
    v_mfma_f32_32x32x16_bf16 v[144:159], v[60:63], v[52:55], v[144:159]
    s_add_u32 s54, s54, 16384
    s_cmp_ge_u32 s54, 81920
    s_cselect_b32 s54, 0, s54
    v_add_u32 v20, s54, v12
    v_add_u32 v21, s54, v13
    v_add_u32 v22, s54, v14
    v_add_u32 v23, s54, v15
    v_add_u32 v24, s54, v16
    v_add_u32 v25, s54, v17
    s_cmp_eq_u32 s49, 7
    s_cbranch_scc1 K1_loop_qk_nb
    s_barrier
K1_loop_qk_nb:
    s_waitcnt lgkmcnt(6)
    v_mfma_f32_32x32x16_bf16 v[96:111], v[72:75], v[64:67], v[96:111]
    ds_read_b128 v[32:35], v20 offset:0
    ds_read_b128 v[36:39], v20 offset:4096
    v_mfma_f32_32x32x16_bf16 v[112:127], v[72:75], v[68:71], v[112:127]
    ds_read_b64_tr_b16 v[40:41], v24 offset:0
    ds_read_b64_tr_b16 v[42:43], v24 offset:1024
    v_mfma_f32_32x32x16_bf16 v[128:143], v[76:79], v[64:67], v[128:143]
    ds_read_b64_tr_b16 v[44:45], v25 offset:0
    ds_read_b64_tr_b16 v[46:47], v25 offset:1024
    v_mfma_f32_32x32x16_bf16 v[144:159], v[76:79], v[68:71], v[144:159]
    s_waitcnt lgkmcnt(6)
    v_mfma_f32_32x32x16_bf16 v[96:111], v[88:91], v[80:83], v[96:111]
    ds_read_b128 v[48:51], v21 offset:0
    ds_read_b128 v[52:55], v21 offset:4096
    v_mfma_f32_32x32x16_bf16 v[112:127], v[88:91], v[84:87], v[112:127]
    ds_read_b64_tr_b16 v[56:57], v24 offset:4096
    ds_read_b64_tr_b16 v[58:59], v24 offset:5120
    v_mfma_f32_32x32x16_bf16 v[128:143], v[92:95], v[80:83], v[128:143]
    ds_read_b64_tr_b16 v[60:61], v25 offset:4096
    ds_read_b64_tr_b16 v[62:63], v25 offset:5120
    v_mfma_f32_32x32x16_bf16 v[144:159], v[92:95], v[84:87], v[144:159]
    s_add_u32 s49, s49, 1
    s_cmp_lt_u32 s49, 8
    s_cbranch_scc1 K1_loop_qk
    s_waitcnt lgkmcnt(0)
    v_lshlrev_b32 v3, 4, v1
    s_nop 7
    v_pk_mul_f32 v[96:97], v[96:97], s[56:57] op_sel_hi:[1,0]
    v_cvt_pk_bf16_f32 v32, v96, v97
    v_pk_mul_f32 v[98:99], v[98:99], s[56:57] op_sel_hi:[1,0]
    v_cvt_pk_bf16_f32 v33, v98, v99
    v_pk_mul_f32 v[100:101], v[100:101], s[56:57] op_sel_hi:[1,0]
    v_cvt_pk_bf16_f32 v34, v100, v101
    v_pk_mul_f32 v[102:103], v[102:103], s[56:57] op_sel_hi:[1,0]
    v_cvt_pk_bf16_f32 v35, v102, v103
    s_add_u32 s54, s53, 0
    buffer_store_dwordx4 v[32:35], v3, s[24:27], s54 offen offset:0 sc1
    v_pk_mul_f32 v[104:105], v[104:105], s[56:57] op_sel_hi:[1,0]
    v_cvt_pk_bf16_f32 v36, v104, v105
    v_pk_mul_f32 v[106:107], v[106:107], s[56:57] op_sel_hi:[1,0]
    v_cvt_pk_bf16_f32 v37, v106, v107
    v_pk_mul_f32 v[108:109], v[108:109], s[56:57] op_sel_hi:[1,0]
    v_cvt_pk_bf16_f32 v38, v108, v109
    v_pk_mul_f32 v[110:111], v[110:111], s[56:57] op_sel_hi:[1,0]
    v_cvt_pk_bf16_f32 v39, v110, v111
    s_add_u32 s54, s53, 65536
    buffer_store_dwordx4 v[36:39], v3, s[24:27], s54 offen offset:0 sc1
    v_pk_mul_f32 v[112:113], v[112:113], s[56:57] op_sel_hi:[1,0]
    v_cvt_pk_bf16_f32 v40, v112, v113
    v_pk_mul_f32 v[114:115], v[114:115], s[56:57] op_sel_hi:[1,0]
    v_cvt_pk_bf16_f32 v41, v114, v115
    v_pk_mul_f32 v[116:117], v[116:117], s[56:57] op_sel_hi:[1,0]
    v_cvt_pk_bf16_f32 v42, v116, v117
    v_pk_mul_f32 v[118:119], v[118:119], s[56:57] op_sel_hi:[1,0]
    v_cvt_pk_bf16_f32 v43, v118, v119
    s_add_u32 s54, s53, 0
    buffer_store_dwordx4 v[40:43], v3, s[24:27], s54 offen offset:1024 sc1
    v_pk_mul_f32 v[120:121], v[120:121], s[56:57] op_sel_hi:[1,0]
    v_cvt_pk_bf16_f32 v44, v120, v121
    v_pk_mul_f32 v[122:123], v[122:123], s[56:57] op_sel_hi:[1,0]
    v_cvt_pk_bf16_f32 v45, v122, v123
    v_pk_mul_f32 v[124:125], v[124:125], s[56:57] op_sel_hi:[1,0]
    v_cvt_pk_bf16_f32 v46, v124, v125
    v_pk_mul_f32 v[126:127], v[126:127], s[56:57] op_sel_hi:[1,0]
    v_cvt_pk_bf16_f32 v47, v126, v127
    s_add_u32 s54, s53, 65536
    buffer_store_dwordx4 v[44:47], v3, s[24:27], s54 offen offset:1024 sc1
    v_pk_mul_f32 v[128:129], v[128:129], s[56:57] op_sel_hi:[1,0]
    v_cvt_pk_bf16_f32 v32, v128, v129
    v_pk_mul_f32 v[130:131], v[130:131], s[56:57] op_sel_hi:[1,0]
    v_cvt_pk_bf16_f32 v33, v130, v131
    v_pk_mul_f32 v[132:133], v[132:133], s[56:57] op_sel_hi:[1,0]
    v_cvt_pk_bf16_f32 v34, v132, v133
    v_pk_mul_f32 v[134:135], v[134:135], s[56:57] op_sel_hi:[1,0]
    v_cvt_pk_bf16_f32 v35, v134, v135
    s_add_u32 s54, s53, 131072
    buffer_store_dwordx4 v[32:35], v3, s[24:27], s54 offen offset:0 sc1
    v_pk_mul_f32 v[136:137], v[136:137], s[56:57] op_sel_hi:[1,0]
    v_cvt_pk_bf16_f32 v36, v136, v137
    v_pk_mul_f32 v[138:139], v[138:139], s[56:57] op_sel_hi:[1,0]
    v_cvt_pk_bf16_f32 v37, v138, v139
    v_pk_mul_f32 v[140:141], v[140:141], s[56:57] op_sel_hi:[1,0]
    v_cvt_pk_bf16_f32 v38, v140, v141
    v_pk_mul_f32 v[142:143], v[142:143], s[56:57] op_sel_hi:[1,0]
    v_cvt_pk_bf16_f32 v39, v142, v143
    s_add_u32 s54, s53, 196608
    buffer_store_dwordx4 v[36:39], v3, s[24:27], s54 offen offset:0 sc1
    s_nop 3
    v_pk_mul_f32 v[144:145], v[144:145], s[56:57] op_sel_hi:[1,0]
    v_cvt_pk_bf16_f32 v40, v144, v145
    v_pk_mul_f32 v[146:147], v[146:147], s[56:57] op_sel_hi:[1,0]
    v_cvt_pk_bf16_f32 v41, v146, v147
    v_pk_mul_f32 v[148:149], v[148:149], s[56:57] op_sel_hi:[1,0]
    v_cvt_pk_bf16_f32 v42, v148, v149
    v_pk_mul_f32 v[150:151], v[150:151], s[56:57] op_sel_hi:[1,0]
    v_cvt_pk_bf16_f32 v43, v150, v151
    s_add_u32 s54, s53, 131072
    buffer_store_dwordx4 v[40:43], v3, s[24:27], s54 offen offset:1024 sc1
    v_pk_mul_f32 v[152:153], v[152:153], s[56:57] op_sel_hi:[1,0]
    v_cvt_pk_bf16_f32 v44, v152, v153
    v_pk_mul_f32 v[154:155], v[154:155], s[56:57] op_sel_hi:[1,0]
    v_cvt_pk_bf16_f32 v45, v154, v155
    v_pk_mul_f32 v[156:157], v[156:157], s[56:57] op_sel_hi:[1,0]
    v_cvt_pk_bf16_f32 v46, v156, v157
    v_pk_mul_f32 v[158:159], v[158:159], s[56:57] op_sel_hi:[1,0]
    v_cvt_pk_bf16_f32 v47, v158, v159
    s_add_u32 s54, s53, 196608
    buffer_store_dwordx4 v[44:47], v3, s[24:27], s54 offen offset:1024 sc1
    s_endpgm
K1_loop_v:
    s_waitcnt lgkmcnt(6)
    v_mfma_f32_32x32x16_bf16 v[96:111], v[32:35], v[40:43], v[96:111]
    ds_read_b128 v[64:67], v22 offset:0
    ds_read_b128 v[68:71], v22 offset:4096
    v_mfma_f32_32x32x16_bf16 v[112:127], v[32:35], v[44:47], v[112:127]
    ds_read_b64_tr_b16 v[72:73], v24 offset:8192
    ds_read_b64_tr_b16 v[74:75], v24 offset:9216
    v_mfma_f32_32x32x16_bf16 v[128:143], v[36:39], v[40:43], v[128:143]
    ds_read_b64_tr_b16 v[76:77], v25 offset:8192
    ds_read_b64_tr_b16 v[78:79], v25 offset:9216
    v_mfma_f32_32x32x16_bf16 v[144:159], v[36:39], v[44:47], v[144:159]
    s_waitcnt lgkmcnt(6)
    v_mfma_f32_32x32x16_bf16 v[96:111], v[48:51], v[56:59], v[96:111]
    ds_read_b128 v[80:83], v23 offset:0
    ds_read_b128 v[84:87], v23 offset:4096
    v_mfma_f32_32x32x16_bf16 v[112:127], v[48:51], v[60:63], v[112:127]
    ds_read_b64_tr_b16 v[88:89], v24 offset:12288
    ds_read_b64_tr_b16 v[90:91], v24 offset:13312
    v_mfma_f32_32x32x16_bf16 v[128:143], v[52:55], v[56:59], v[128:143]
    ds_read_b64_tr_b16 v[92:93], v25 offset:12288
    ds_read_b64_tr_b16 v[94:95], v25 offset:13312
    v_mfma_f32_32x32x16_bf16 v[144:159], v[52:55], v[60:63], v[144:159]
    s_add_u32 s54, s54, 16384
    s_cmp_ge_u32 s54, 81920
    s_cselect_b32 s54, 0, s54
    v_add_u32 v20, s54, v12
    v_add_u32 v21, s54, v13
    v_add_u32 v22, s54, v14
    v_add_u32 v23, s54, v15
    v_add_u32 v24, s54, v16
    v_add_u32 v25, s54, v17
    s_cmp_eq_u32 s49, 7
    s_cbranch_scc1 K1_loop_v_nb
    s_barrier
K1_loop_v_nb:
    s_waitcnt lgkmcnt(6)
    v_mfma_f32_32x32x16_bf16 v[96:111], v[64:67], v[72:75], v[96:111]
    ds_read_b128 v[32:35], v20 offset:0
    ds_read_b128 v[36:39], v20 offset:4096
    v_mfma_f32_32x32x16_bf16 v[112:127], v[64:67], v[76:79], v[112:127]
    ds_read_b64_tr_b16 v[40:41], v24 offset:0
    ds_read_b64_tr_b16 v[42:43], v24 offset:1024
    v_mfma_f32_32x32x16_bf16 v[128:143], v[68:71], v[72:75], v[128:143]
    ds_read_b64_tr_b16 v[44:45], v25 offset:0
    ds_read_b64_tr_b16 v[46:47], v25 offset:1024
    v_mfma_f32_32x32x16_bf16 v[144:159], v[68:71], v[76:79], v[144:159]
    s_waitcnt lgkmcnt(6)
    v_mfma_f32_32x32x16_bf16 v[96:111], v[80:83], v[88:91], v[96:111]
    ds_read_b128 v[48:51], v21 offset:0
    ds_read_b128 v[52:55], v21 offset:4096
    v_mfma_f32_32x32x16_bf16 v[112:127], v[80:83], v[92:95], v[112:127]
    ds_read_b64_tr_b16 v[56:57], v24 offset:4096
    ds_read_b64_tr_b16 v[58:59], v24 offset:5120
    v_mfma_f32_32x32x16_bf16 v[128:143], v[84:87], v[88:91], v[128:143]
    ds_read_b64_tr_b16 v[60:61], v25 offset:4096
    ds_read_b64_tr_b16 v[62:63], v25 offset:5120
    v_mfma_f32_32x32x16_bf16 v[144:159], v[84:87], v[92:95], v[144:159]
    s_add_u32 s49, s49, 1
    s_cmp_lt_u32 s49, 8
    s_cbranch_scc1 K1_loop_v
    s_waitcnt lgkmcnt(0)
    v_bfe_u32 v3, v1, 4, 1
    v_lshlrev_b32 v3, 16, v3
    v_lshrrev_b32 v4, 5, v1
    v_lshl_add_u32 v3, v4, 8, v3
    v_and_b32 v4, 15, v1
    v_lshl_add_u32 v3, v4, 4, v3
    s_nop 7
    v_cvt_pk_bf16_f32 v32, v96, v97
    v_cvt_pk_bf16_f32 v33, v98, v99
    v_cvt_pk_bf16_f32 v34, v100, v101
    v_cvt_pk_bf16_f32 v35, v102, v103
    s_add_u32 s54, s53, 0
    buffer_store_dwordx4 v[32:35], v3, s[24:27], s54 offen offset:0 sc1
    v_cvt_pk_bf16_f32 v36, v104, v105
    v_cvt_pk_bf16_f32 v37, v106, v107
    v_cvt_pk_bf16_f32 v38, v108, v109
    v_cvt_pk_bf16_f32 v39, v110, v111
    s_add_u32 s54, s53, 0
    buffer_store_dwordx4 v[36:39], v3, s[24:27], s54 offen offset:512 sc1
    v_cvt_pk_bf16_f32 v40, v112, v113
    v_cvt_pk_bf16_f32 v41, v114, v115
    v_cvt_pk_bf16_f32 v42, v116, v117
    v_cvt_pk_bf16_f32 v43, v118, v119
    s_add_u32 s54, s53, 131072
    buffer_store_dwordx4 v[40:43], v3, s[24:27], s54 offen offset:0 sc1
    v_cvt_pk_bf16_f32 v44, v120, v121
    v_cvt_pk_bf16_f32 v45, v122, v123
    v_cvt_pk_bf16_f32 v46, v124, v125
    v_cvt_pk_bf16_f32 v47, v126, v127
    s_add_u32 s54, s53, 131072
    buffer_store_dwordx4 v[44:47], v3, s[24:27], s54 offen offset:512 sc1
    v_cvt_pk_bf16_f32 v32, v128, v129
    v_cvt_pk_bf16_f32 v33, v130, v131
    v_cvt_pk_bf16_f32 v34, v132, v133
    v_cvt_pk_bf16_f32 v35, v134, v135
    s_add_u32 s54, s53, 0
    buffer_store_dwordx4 v[32:35], v3, s[24:27], s54 offen offset:1024 sc1
    v_cvt_pk_bf16_f32 v36, v136, v137
    v_cvt_pk_bf16_f32 v37, v138, v139
    v_cvt_pk_bf16_f32 v38, v140, v141
    v_cvt_pk_bf16_f32 v39, v142, v143
    s_add_u32 s54, s53, 0
    buffer_store_dwordx4 v[36:39], v3, s[24:27], s54 offen offset:1536 sc1
    s_nop 3
    v_cvt_pk_bf16_f32 v40, v144, v145
    v_cvt_pk_bf16_f32 v41, v146, v147
    v_cvt_pk_bf16_f32 v42, v148, v149
    v_cvt_pk_bf16_f32 v43, v150, v151
    s_add_u32 s54, s53, 131072
    buffer_store_dwordx4 v[40:43], v3, s[24:27], s54 offen offset:1024 sc1
    v_cvt_pk_bf16_f32 v44, v152, v153
    v_cvt_pk_bf16_f32 v45, v154, v155
    v_cvt_pk_bf16_f32 v46, v156, v157
    v_cvt_pk_bf16_f32 v47, v158, v159
    s_add_u32 s54, s53, 131072
    buffer_store_dwordx4 v[44:47], v3, s[24:27], s54 offen offset:1536 sc1
    s_endpgm
K1_aux:
    s_sub_u32 s36, s35, 24
    s_lshl_b32 s37, s34, 3
    s_add_u32 s36, s36, s37
    v_lshrrev_b32 v3, 4, v1
    v_and_b32 v4, 15, v1
    v_lshlrev_b32 v5, 4, v4
    v_lshl_add_u32 v6, v3, 10, v5
    v_lshlrev_b32 v7, 4, v1
    s_lshl_b32 s37, s36, 15
    s_lshl_b32 s38, s33, 12
    s_add_u32 s37, s37, s38
    s_waitcnt lgkmcnt(0)
    s_mov_b32 s16, s4
    s_and_b32 s17, s5, 0xffff
    s_mov_b32 s18, 0x200000
    s_mov_b32 s19, 0x00020000
    s_mov_b32 s28, s10
    s_and_b32 s29, s11, 0xffff
    s_mov_b32 s30, 0x400
    s_mov_b32 s31, 0x00020000
    buffer_load_dwordx4 v[32:35], v6, s[16:19], s37 offen offset:0
    buffer_load_dwordx4 v[36:39], v6, s[16:19], s37 offen offset:256
    buffer_load_dwordx4 v[40:43], v6, s[16:19], s37 offen offset:512
    buffer_load_dwordx4 v[44:47], v6, s[16:19], s37 offen offset:768
    buffer_load_dwordx4 v[48:51], v5, s[28:31], 0 offen offset:0
    buffer_load_dwordx4 v[52:55], v5, s[28:31], 0 offen offset:256
    buffer_load_dwordx4 v[56:59], v5, s[28:31], 0 offen offset:512
    buffer_load_dwordx4 v[60:63], v5, s[28:31], 0 offen offset:768
    s_mov_b32 s20, s8
    s_and_b32 s21, s9, 0xffff
    s_mov_b32 s22, 0x560000
    s_mov_b32 s23, 0x00020000
    s_mov_b32 s24, s12
    s_and_b32 s25, s13, 0xffff
    s_mov_b32 s26, 0x1300000
    s_mov_b32 s27, 0x00020000
    s_lshl_b32 s43, s36, 4
    s_lshl_b32 s44, s33, 1
    s_add_u32 s43, s43, s44
    s_mul_i32 s44, s43, 5504
    s_add_u32 s44, s44, 2752
    s_add_u32 s45, s44, 5504
    s_lshl_b32 s46, s43, 7
    s_add_u32 s46, s46, 9437184
    v_lshrrev_b32 v31, 3, v1
    v_lshlrev_b32 v31, 17, v31
    v_and_b32 v27, 7, v1
    v_lshl_add_u32 v31, v27, 4, v31
    s_mul_i32 s38, s34, 640
    s_sub_u32 s39, s34, 4
    s_mul_i32 s39, s39, 768
    s_cmp_lt_u32 s34, 4
    s_cselect_b32 s38, s38, s39
    s_movk_i32 s39, 640
    s_cselect_b32 s39, 512, s39
    s_cmp_eq_u32 s34, 7
    s_cselect_b32 s39, 384, s39
    v_and_b32 v28, 7, v1
    v_lshlrev_b32 v28, 7, v28
    v_min_u32 v28, s39, v28
    v_lshrrev_b32 v9, 3, v1
    v_mul_u32_u24 v9, 5504, v9
    v_add_u32 v28, v28, v9
    s_sub_u32 s40, s35, 24
    s_lshl_b32 s40, s40, 3
    s_add_u32 s40, s40, s33
    s_mul_i32 s40, s40, 44032
    s_add_u32 s38, s38, s40
    v_bfe_u32 v29, v1, 2, 2
    v_lshl_add_u32 v29, v3, 2, v29
    v_and_b32 v30, 3, v1
    v_lshlrev_b32 v30, 3, v30
    v_mul_u32_u24 v29, 2080, v29
    v_add_u32 v29, v29, v30
    s_lshl_b32 s41, s33, 7
    v_add_u32 v29, s41, v29
    s_mul_i32 s40, s36, 3072
    s_add_u32 s40, s40, 6291456
    s_lshl_b32 s41, s33, 2
    s_add_u32 s41, s41, 0
    s_cmp_ge_u32 s41, 30
    s_addc_u32 s41, s41, 0
    s_mul_i32 s42, s41, 43
    s_lshr_b32 s42, s42, 7
    s_mul_i32 s50, s42, 3
    s_sub_u32 s41, s41, s50
    s_lshl_b32 s41, s41, 10
    s_mul_i32 s42, s42, 196608
    s_add_u32 s41, s41, s42
    s_add_u32 s52, s41, s40
    s_lshl_b32 s41, s33, 2
    s_add_u32 s41, s41, 1
    s_cmp_ge_u32 s41, 30
    s_addc_u32 s41, s41, 0
    s_mul_i32 s42, s41, 43
    s_lshr_b32 s42, s42, 7
    s_mul_i32 s50, s42, 3
    s_sub_u32 s41, s41, s50
    s_lshl_b32 s41, s41, 10
    s_mul_i32 s42, s42, 196608
    s_add_u32 s41, s41, s42
    s_add_u32 s53, s41, s40
    s_lshl_b32 s41, s33, 2
    s_add_u32 s41, s41, 2
    s_cmp_ge_u32 s41, 30
    s_addc_u32 s41, s41, 0
    s_mul_i32 s42, s41, 43
    s_lshr_b32 s42, s42, 7
    s_mul_i32 s50, s42, 3
    s_sub_u32 s41, s41, s50
    s_lshl_b32 s41, s41, 10
    s_mul_i32 s42, s42, 196608
    s_add_u32 s41, s41, s42
    s_add_u32 s54, s41, s40
    s_lshl_b32 s41, s33, 2
    s_add_u32 s41, s41, 3
    s_cmp_ge_u32 s41, 30
    s_addc_u32 s41, s41, 0
    s_mul_i32 s42, s41, 43
    s_lshr_b32 s42, s42, 7
    s_mul_i32 s50, s42, 3
    s_sub_u32 s41, s41, s50
    s_lshl_b32 s41, s41, 10
    s_mul_i32 s42, s42, 196608
    s_add_u32 s41, s41, s42
    s_add_u32 s55, s41, s40
    s_lshl_b32 s42, s36, 7
    s_lshl_b32 s41, s33, 4
    s_add_u32 s42, s42, s41
    s_add_u32 s42, s42, 14680064
    s_lshl_b32 s41, s33, 2
    v_add_u32 v9, s41, v3
    v_mul_u32_u24 v9, 1040, v9
    v_add_u32 v9, v9, v5
    v_lshlrev_b32 v30, 2, v3
    v_mov_b32 v8, 0x3f803f80
    v_mov_b64 v[10:11], 0
    v_mov_b64 v[12:13], 0
    buffer_load_dwordx4 v[96:99], v7, s[20:23], s44 offen offset:0
    buffer_load_dwordx4 v[100:103], v7, s[20:23], s44 offen offset:1024
    buffer_load_dwordx4 v[104:107], v7, s[20:23], s44 offen offset:2048
    buffer_load_dwordx4 v[108:111], v7, s[20:23], s45 offen offset:0
    buffer_load_dwordx4 v[112:115], v7, s[20:23], s45 offen offset:1024
    buffer_load_dwordx4 v[116:119], v7, s[20:23], s45 offen offset:2048
    s_barrier
    buffer_load_dword v24, v28, s[20:23], s38 offen
    s_add_u32 s38, s38, 2818048
    buffer_load_dword v25, v28, s[20:23], s38 offen
    s_add_u32 s38, s38, 2818048
    s_waitcnt vmcnt(8)
    v_dot2c_f32_bf16 v10, v32, v8
    v_dot2c_f32_bf16 v12, v32, v48
    v_dot2c_f32_bf16 v11, v33, v8
    v_dot2c_f32_bf16 v13, v33, v49
    v_dot2c_f32_bf16 v10, v34, v8
    v_dot2c_f32_bf16 v12, v34, v50
    v_dot2c_f32_bf16 v11, v35, v8
    v_dot2c_f32_bf16 v13, v35, v51
    v_dot2c_f32_bf16 v10, v36, v8
    v_dot2c_f32_bf16 v12, v36, v52
    v_dot2c_f32_bf16 v11, v37, v8
    v_dot2c_f32_bf16 v13, v37, v53
    v_dot2c_f32_bf16 v10, v38, v8
    v_dot2c_f32_bf16 v12, v38, v54
    v_dot2c_f32_bf16 v11, v39, v8
    v_dot2c_f32_bf16 v13, v39, v55
    v_dot2c_f32_bf16 v10, v40, v8
    v_dot2c_f32_bf16 v12, v40, v56
    v_dot2c_f32_bf16 v11, v41, v8
    v_dot2c_f32_bf16 v13, v41, v57
    v_dot2c_f32_bf16 v10, v42, v8
    v_dot2c_f32_bf16 v12, v42, v58
    v_dot2c_f32_bf16 v11, v43, v8
    v_dot2c_f32_bf16 v13, v43, v59
    v_dot2c_f32_bf16 v10, v44, v8
    v_dot2c_f32_bf16 v12, v44, v60
    v_dot2c_f32_bf16 v11, v45, v8
    v_dot2c_f32_bf16 v13, v45, v61
    v_dot2c_f32_bf16 v10, v46, v8
    v_dot2c_f32_bf16 v12, v46, v62
    v_dot2c_f32_bf16 v11, v47, v8
    v_dot2c_f32_bf16 v13, v47, v63
    v_lshlrev_b32 v64, 16, v32
    v_and_b32 v65, 0xffff0000, v32
    v_lshlrev_b32 v66, 16, v33
    v_and_b32 v67, 0xffff0000, v33
    v_lshlrev_b32 v68, 16, v34
    v_and_b32 v69, 0xffff0000, v34
    v_lshlrev_b32 v70, 16, v35
    v_and_b32 v71, 0xffff0000, v35
    v_lshlrev_b32 v72, 16, v36
    v_and_b32 v73, 0xffff0000, v36
    v_lshlrev_b32 v74, 16, v37
    v_and_b32 v75, 0xffff0000, v37
    v_lshlrev_b32 v76, 16, v38
    v_and_b32 v77, 0xffff0000, v38
    v_lshlrev_b32 v78, 16, v39
    v_and_b32 v79, 0xffff0000, v39
    v_lshlrev_b32 v80, 16, v40
    v_and_b32 v81, 0xffff0000, v40
    v_lshlrev_b32 v82, 16, v41
    v_and_b32 v83, 0xffff0000, v41
    v_lshlrev_b32 v84, 16, v42
    v_and_b32 v85, 0xffff0000, v42
    v_lshlrev_b32 v86, 16, v43
    v_and_b32 v87, 0xffff0000, v43
    v_lshlrev_b32 v88, 16, v44
    v_and_b32 v89, 0xffff0000, v44
    v_lshlrev_b32 v90, 16, v45
    v_and_b32 v91, 0xffff0000, v45
    v_lshlrev_b32 v92, 16, v46
    v_and_b32 v93, 0xffff0000, v46
    v_lshlrev_b32 v94, 16, v47
    v_and_b32 v95, 0xffff0000, v47
    v_add_f32 v10, v10, v11
    v_add_f32 v12, v12, v13
    s_nop 1
    v_add_f32_dpp v10, v10, v10 quad_perm:[1,0,3,2] row_mask:0xf bank_mask:0xf
    v_add_f32_dpp v12, v12, v12 quad_perm:[1,0,3,2] row_mask:0xf bank_mask:0xf
    s_nop 1
    v_add_f32_dpp v10, v10, v10 quad_perm:[2,3,0,1] row_mask:0xf bank_mask:0xf
    v_add_f32_dpp v12, v12, v12 quad_perm:[2,3,0,1] row_mask:0xf bank_mask:0xf
    s_nop 1
    v_add_f32_dpp v10, v10, v10 row_half_mirror row_mask:0xf bank_mask:0xf
    v_add_f32_dpp v12, v12, v12 row_half_mirror row_mask:0xf bank_mask:0xf
    s_nop 1
    v_add_f32_dpp v10, v10, v10 row_mirror row_mask:0xf bank_mask:0xf
    v_add_f32_dpp v12, v12, v12 row_mirror row_mask:0xf bank_mask:0xf
    v_mul_f32 v14, 0x3b000000, v10
    v_mov_b64 v[16:17], 0
    v_mov_b64 v[18:19], 0
    v_pk_add_f32 v[64:65], v[64:65], v[14:15] op_sel_hi:[1,0] neg_lo:[0,1] neg_hi:[0,1]
    v_pk_add_f32 v[66:67], v[66:67], v[14:15] op_sel_hi:[1,0] neg_lo:[0,1] neg_hi:[0,1]
    v_pk_add_f32 v[68:69], v[68:69], v[14:15] op_sel_hi:[1,0] neg_lo:[0,1] neg_hi:[0,1]
    v_pk_add_f32 v[70:71], v[70:71], v[14:15] op_sel_hi:[1,0] neg_lo:[0,1] neg_hi:[0,1]
    v_pk_add_f32 v[72:73], v[72:73], v[14:15] op_sel_hi:[1,0] neg_lo:[0,1] neg_hi:[0,1]
    v_pk_add_f32 v[74:75], v[74:75], v[14:15] op_sel_hi:[1,0] neg_lo:[0,1] neg_hi:[0,1]
    v_pk_add_f32 v[76:77], v[76:77], v[14:15] op_sel_hi:[1,0] neg_lo:[0,1] neg_hi:[0,1]
    v_pk_add_f32 v[78:79], v[78:79], v[14:15] op_sel_hi:[1,0] neg_lo:[0,1] neg_hi:[0,1]
    v_pk_add_f32 v[80:81], v[80:81], v[14:15] op_sel_hi:[1,0] neg_lo:[0,1] neg_hi:[0,1]
    v_pk_add_f32 v[82:83], v[82:83], v[14:15] op_sel_hi:[1,0] neg_lo:[0,1] neg_hi:[0,1]
    v_pk_add_f32 v[84:85], v[84:85], v[14:15] op_sel_hi:[1,0] neg_lo:[0,1] neg_hi:[0,1]
    v_pk_add_f32 v[86:87], v[86:87], v[14:15] op_sel_hi:[1,0] neg_lo:[0,1] neg_hi:[0,1]
    v_pk_add_f32 v[88:89], v[88:89], v[14:15] op_sel_hi:[1,0] neg_lo:[0,1] neg_hi:[0,1]
    v_pk_add_f32 v[90:91], v[90:91], v[14:15] op_sel_hi:[1,0] neg_lo:[0,1] neg_hi:[0,1]
    v_pk_add_f32 v[92:93], v[92:93], v[14:15] op_sel_hi:[1,0] neg_lo:[0,1] neg_hi:[0,1]
    v_pk_add_f32 v[94:95], v[94:95], v[14:15] op_sel_hi:[1,0] neg_lo:[0,1] neg_hi:[0,1]
    v_pk_fma_f32 v[16:17], v[64:65], v[64:65], v[16:17]
    v_pk_fma_f32 v[18:19], v[66:67], v[66:67], v[18:19]
    v_pk_fma_f32 v[16:17], v[68:69], v[68:69], v[16:17]
    v_pk_fma_f32 v[18:19], v[70:71], v[70:71], v[18:19]
    v_pk_fma_f32 v[16:17], v[72:73], v[72:73], v[16:17]
    v_pk_fma_f32 v[18:19], v[74:75], v[74:75], v[18:19]
    v_pk_fma_f32 v[16:17], v[76:77], v[76:77], v[16:17]
    v_pk_fma_f32 v[18:19], v[78:79], v[78:79], v[18:19]
    v_pk_fma_f32 v[16:17], v[80:81], v[80:81], v[16:17]
    v_pk_fma_f32 v[18:19], v[82:83], v[82:83], v[18:19]
    v_pk_fma_f32 v[16:17], v[84:85], v[84:85], v[16:17]
    v_pk_fma_f32 v[18:19], v[86:87], v[86:87], v[18:19]
    v_pk_fma_f32 v[16:17], v[88:89], v[88:89], v[16:17]
    v_pk_fma_f32 v[18:19], v[90:91], v[90:91], v[18:19]
    v_pk_fma_f32 v[16:17], v[92:93], v[92:93], v[16:17]
    v_pk_fma_f32 v[18:19], v[94:95], v[94:95], v[18:19]
    v_add_f32 v16, v16, v17
    v_add_f32 v18, v18, v19
    v_add_f32 v16, v16, v18
    s_nop 1
    v_add_f32_dpp v16, v16, v16 quad_perm:[1,0,3,2] row_mask:0xf bank_mask:0xf
    s_nop 1
    v_add_f32_dpp v16, v16, v16 quad_perm:[2,3,0,1] row_mask:0xf bank_mask:0xf
    s_nop 1
    v_add_f32_dpp v16, v16, v16 row_half_mirror row_mask:0xf bank_mask:0xf
    s_nop 1
    v_add_f32_dpp v16, v16, v16 row_mirror row_mask:0xf bank_mask:0xf
    v_mul_f32 v16, 0x3b000000, v16
    v_cvt_pk_bf16_f32 v16, v16, v14
    v_cvt_pk_bf16_f32 v12, v12, v12
    v_and_b32 v17, 0xffff0000, v16
    v_lshlrev_b32 v16, 16, v16
    v_lshlrev_b32 v12, 16, v12
    v_add_f32 v16, 0x3727c5ac, v16
    v_mul_f32 v12, 0xbfb8aa3b, v12
    v_cvt_pk_bf16_f32 v16, v16, v16
    v_exp_f32 v12, v12
    v_lshlrev_b32 v16, 16, v16
    v_sqrt_f32 v16, v16
    v_add_f32 v12, 1.0, v12
    v_cvt_pk_bf16_f32 v16, v16, v16
    v_rcp_f32 v12, v12
    v_lshlrev_b32 v16, 16, v16
    v_rcp_f32 v20, v16
    v_sub_f32 v18, v14, v17
    v_cvt_pk_bf16_f32 v12, v12, v12
    v_mul_f32 v22, v18, v20
    v_lshlrev_b32 v12, 16, v12
    v_pk_fma_f32 v[64:65], v[64:65], v[20:21], v[22:23] op_sel_hi:[1,0,0]
    v_pk_fma_f32 v[66:67], v[66:67], v[20:21], v[22:23] op_sel_hi:[1,0,0]
    v_pk_fma_f32 v[68:69], v[68:69], v[20:21], v[22:23] op_sel_hi:[1,0,0]
    v_pk_fma_f32 v[70:71], v[70:71], v[20:21], v[22:23] op_sel_hi:[1,0,0]
    v_cvt_pk_bf16_f32 v32, v64, v65
    v_cvt_pk_bf16_f32 v33, v66, v67
    v_cvt_pk_bf16_f32 v34, v68, v69
    v_cvt_pk_bf16_f32 v35, v70, v71
    ds_write_b128 v9, v[32:35] offset:0
    v_pk_fma_f32 v[72:73], v[72:73], v[20:21], v[22:23] op_sel_hi:[1,0,0]
    v_pk_fma_f32 v[74:75], v[74:75], v[20:21], v[22:23] op_sel_hi:[1,0,0]
    v_pk_fma_f32 v[76:77], v[76:77], v[20:21], v[22:23] op_sel_hi:[1,0,0]
    v_pk_fma_f32 v[78:79], v[78:79], v[20:21], v[22:23] op_sel_hi:[1,0,0]
    v_cvt_pk_bf16_f32 v36, v72, v73
    v_cvt_pk_bf16_f32 v37, v74, v75
    v_cvt_pk_bf16_f32 v38, v76, v77
    v_cvt_pk_bf16_f32 v39, v78, v79
    ds_write_b128 v9, v[36:39] offset:256
    v_pk_fma_f32 v[80:81], v[80:81], v[20:21], v[22:23] op_sel_hi:[1,0,0]
    v_pk_fma_f32 v[82:83], v[82:83], v[20:21], v[22:23] op_sel_hi:[1,0,0]
    v_pk_fma_f32 v[84:85], v[84:85], v[20:21], v[22:23] op_sel_hi:[1,0,0]
    v_pk_fma_f32 v[86:87], v[86:87], v[20:21], v[22:23] op_sel_hi:[1,0,0]
    v_cvt_pk_bf16_f32 v40, v80, v81
    v_cvt_pk_bf16_f32 v41, v82, v83
    v_cvt_pk_bf16_f32 v42, v84, v85
    v_cvt_pk_bf16_f32 v43, v86, v87
    ds_write_b128 v9, v[40:43] offset:512
    v_pk_fma_f32 v[88:89], v[88:89], v[20:21], v[22:23] op_sel_hi:[1,0,0]
    v_pk_fma_f32 v[90:91], v[90:91], v[20:21], v[22:23] op_sel_hi:[1,0,0]
    v_pk_fma_f32 v[92:93], v[92:93], v[20:21], v[22:23] op_sel_hi:[1,0,0]
    v_pk_fma_f32 v[94:95], v[94:95], v[20:21], v[22:23] op_sel_hi:[1,0,0]
    v_cvt_pk_bf16_f32 v44, v88, v89
    v_cvt_pk_bf16_f32 v45, v90, v91
    v_cvt_pk_bf16_f32 v46, v92, v93
    v_cvt_pk_bf16_f32 v47, v94, v95
    ds_write_b128 v9, v[44:47] offset:768
    buffer_store_dword v12, v30, s[24:27], s42 offen sc1
    s_waitcnt lgkmcnt(0)
    s_barrier
    ds_read_b64_tr_b16 v[32:33], v29 offset:0
    ds_read_b64_tr_b16 v[34:35], v29 offset:1040
    ds_read_b64_tr_b16 v[36:37], v29 offset:32
    ds_read_b64_tr_b16 v[38:39], v29 offset:1072
    ds_read_b64_tr_b16 v[40:41], v29 offset:64
    ds_read_b64_tr_b16 v[42:43], v29 offset:1104
    ds_read_b64_tr_b16 v[44:45], v29 offset:96
    ds_read_b64_tr_b16 v[46:47], v29 offset:1136
    s_waitcnt lgkmcnt(6)
    buffer_store_dwordx4 v[32:35], v7, s[24:27], s52 offen sc1
    s_waitcnt lgkmcnt(4)
    buffer_store_dwordx4 v[36:39], v7, s[24:27], s53 offen sc1
    s_waitcnt lgkmcnt(2)
    buffer_store_dwordx4 v[40:43], v7, s[24:27], s54 offen sc1
    s_waitcnt lgkmcnt(0)
    buffer_store_dwordx4 v[44:47], v7, s[24:27], s55 offen sc1
    s_waitcnt vmcnt(7)
    s_cmp_eq_u32 s33, 7
    s_cbranch_scc0 K1_nx
    s_add_u32 s41, s40, 1966080
    buffer_store_dwordx4 v[36:39], v7, s[24:27], s41 offen sc1
K1_nx:
    s_mov_b32 s48, -1
    s_mov_b32 s49, 0xffff
    s_add_u32 s47, s46, 0
    buffer_store_dwordx4 v[96:99], v31, s[24:27], s47 offen offset:0 sc1
    s_add_u32 s47, s46, 1048576
    buffer_store_dwordx4 v[100:103], v31, s[24:27], s47 offen offset:0 sc1
    s_mov_b64 exec, s[48:49]
    s_add_u32 s47, s46, 2097152
    buffer_store_dwordx4 v[104:107], v31, s[24:27], s47 offen offset:0 sc1
    s_mov_b64 exec, -1
    s_add_u32 s47, s46, 0
    buffer_store_dwordx4 v[108:111], v31, s[24:27], s47 offen offset:128 sc1
    s_add_u32 s47, s46, 1048576
    buffer_store_dwordx4 v[112:115], v31, s[24:27], s47 offen offset:128 sc1
    s_mov_b64 exec, s[48:49]
    s_add_u32 s47, s46, 2097152
    buffer_store_dwordx4 v[116:119], v31, s[24:27], s47 offen offset:128 sc1
    s_mov_b64 exec, -1
K1_end:
    s_endpgm
.globl k2_kernel
.p2align 8
.type k2_kernel,@function
k2_kernel:
    s_cmp_ge_u32 s2, 256
    s_cbranch_scc1 K2_end
    s_load_dwordx4 s[8:11], s[0:1], 32
    s_load_dwordx2 s[12:13], s[0:1], 88
    s_load_dwordx2 s[4:5], s[0:1], 16
    s_load_dwordx2 s[6:7], s[0:1], 48
    v_and_b32 v1, 63, v0
    v_lshrrev_b32 v2, 6, v0
    s_and_b32 s34, s2, 7
    v_readfirstlane_b32 s33, v2
    s_lshr_b32 s35, s2, 3
    v_lshlrev_b32 v2, 4, v1
    v_mov_b32 v3, 33280
    v_mov_b64 v[4:5], 0
    ds_write_b64 v3, v[4:5]
    ds_write_b64 v3, v[4:5] offset:8
    s_waitcnt lgkmcnt(0)
    s_barrier
    s_xor_b32 s33, s33, 4
    s_cmp_lt_u32 s33, 4
    s_cbranch_scc1 K2_attn
    s_sub_u32 s33, s33, 4
    s_cmp_eq_u32 s34, 7
    s_cbranch_scc1 K2_d7
    s_cmp_ge_u32 s35, 30
    s_cbranch_scc1 K2_pref
    s_cmp_lt_u32 s34, 4
    s_cbranch_scc0 K2_d5
    s_mul_i32 s36, s34, 5
    s_mov_b32 s37, s35
K2_d6:
    s_mul_i32 s38, s37, 43
    s_lshr_b32 s38, s38, 8
    s_mul_i32 s39, s38, 6
    s_sub_u32 s39, s37, s39
    s_add_u32 s38, s38, s36
    s_branch K2_dd
K2_d7:
    s_mov_b32 s36, 20
    s_sub_u32 s37, s35, 20
    s_cmp_ge_u32 s35, 20
    s_cbranch_scc1 K2_d6
K2_d5:
    s_sub_u32 s36, s34, 4
    s_mul_i32 s36, s36, 6
    s_mul_i32 s38, s35, 52
    s_lshr_b32 s38, s38, 8
    s_mul_i32 s39, s38, 5
    s_sub_u32 s39, s35, s39
    s_add_u32 s39, s39, 6
    s_add_u32 s38, s38, s36
K2_dd:
    v_lshrrev_b32 v3, 3, v1
    v_lshlrev_b32 v153, 7, v3
    v_mul_u32_u24 v3, 5504, v3
    v_lshrrev_b32 v4, 4, v1
    v_lshlrev_b32 v4, 1, v4
    v_and_b32 v5, 7, v1
    v_xor_b32 v4, v4, v5
    v_lshl_add_u32 v3, v4, 4, v3
    v_lshl_add_u32 v153, v4, 4, v153
    s_mul_i32 s54, s33, 1409024
    s_lshl_b32 s40, s38, 7
    s_add_u32 s54, s54, s40
    s_lshl_b32 s53, s33, 15
    s_lshl_b32 s40, s38, 17
    s_add_u32 s53, s53, s40
    s_add_u32 s53, s53, 9437184
    s_mul_i32 s55, s33, 49152
    s_mul_i32 s40, s39, 196608
    s_add_u32 s55, s55, s40
    s_add_u32 s55, s55, 6291456
    s_mul_i32 s40, s33, 24576
    s_add_u32 s40, s40, 33792
    s_waitcnt lgkmcnt(0)
    s_mov_b32 s16, s8
    s_and_b32 s17, s9, 0xffff
    s_mov_b32 s18, 0x560000
    s_mov_b32 s19, 0x00020000
    s_mov_b32 s24, s12
    s_and_b32 s25, s13, 0xffff
    s_mov_b32 s26, 0x1300000
    s_mov_b32 s27, 0x00020000
    s_add_u32 m0, s40, 0
    s_add_u32 s50, s54, 0
    buffer_load_dwordx4 v3, s[16:19], s50 offen lds
    s_add_u32 m0, s40, 1024
    s_add_u32 s50, s54, 44032
    buffer_load_dwordx4 v3, s[16:19], s50 offen lds
    s_add_u32 m0, s40, 2048
    s_add_u32 s50, s53, 0
    buffer_load_dwordx4 v153, s[24:27], s50 offen lds
    s_add_u32 m0, s40, 3072
    s_add_u32 s50, s53, 1024
    buffer_load_dwordx4 v153, s[24:27], s50 offen lds
    buffer_load_dwordx4 v[160:163], v2, s[24:27], s55 offen offset:0
    buffer_load_dwordx4 v[164:167], v2, s[24:27], s55 offen offset:1024
    buffer_load_dwordx4 v[168:171], v2, s[24:27], s55 offen offset:2048
    s_add_u32 s54, s54, 88064
    s_add_u32 s53, s53, 2048
    s_add_u32 s55, s55, 3072
    s_add_u32 m0, s40, 4096
    s_add_u32 s50, s54, 0
    buffer_load_dwordx4 v3, s[16:19], s50 offen lds
    s_add_u32 m0, s40, 5120
    s_add_u32 s50, s54, 44032
    buffer_load_dwordx4 v3, s[16:19], s50 offen lds
    s_add_u32 m0, s40, 6144
    s_add_u32 s50, s53, 0
    buffer_load_dwordx4 v153, s[24:27], s50 offen lds
    s_add_u32 m0, s40, 7168
    s_add_u32 s50, s53, 1024
    buffer_load_dwordx4 v153, s[24:27], s50 offen lds
    buffer_load_dwordx4 v[172:175], v2, s[24:27], s55 offen offset:0
    buffer_load_dwordx4 v[176:179], v2, s[24:27], s55 offen offset:1024
    buffer_load_dwordx4 v[180:183], v2, s[24:27], s55 offen offset:2048
    s_add_u32 s54, s54, 88064
    s_add_u32 s53, s53, 2048
    s_add_u32 s55, s55, 3072
    s_add_u32 m0, s40, 8192
    s_add_u32 s50, s54, 0
    buffer_load_dwordx4 v3, s[16:19], s50 offen lds
    s_add_u32 m0, s40, 9216
    s_add_u32 s50, s54, 44032
    buffer_load_dwordx4 v3, s[16:19], s50 offen lds
    s_add_u32 m0, s40, 10240
    s_add_u32 s50, s53, 0
    buffer_load_dwordx4 v153, s[24:27], s50 offen lds
    s_add_u32 m0, s40, 11264
    s_add_u32 s50, s53, 1024
    buffer_load_dwordx4 v153, s[24:27], s50 offen lds
    buffer_load_dwordx4 v[184:187], v2, s[24:27], s55 offen offset:0
    buffer_load_dwordx4 v[188:191], v2, s[24:27], s55 offen offset:1024
    buffer_load_dwordx4 v[192:195], v2, s[24:27], s55 offen offset:2048
    s_add_u32 s54, s54, 88064
    s_add_u32 s53, s53, 2048
    s_add_u32 s55, s55, 3072
    s_add_u32 m0, s40, 12288
    s_add_u32 s50, s54, 0
    buffer_load_dwordx4 v3, s[16:19], s50 offen lds
    s_add_u32 m0, s40, 13312
    s_add_u32 s50, s54, 44032
    buffer_load_dwordx4 v3, s[16:19], s50 offen lds
    s_add_u32 m0, s40, 14336
    s_add_u32 s50, s53, 0
    buffer_load_dwordx4 v153, s[24:27], s50 offen lds
    s_add_u32 m0, s40, 15360
    s_add_u32 s50, s53, 1024
    buffer_load_dwordx4 v153, s[24:27], s50 offen lds
    buffer_load_dwordx4 v[196:199], v2, s[24:27], s55 offen offset:0
    buffer_load_dwordx4 v[200:203], v2, s[24:27], s55 offen offset:1024
    buffer_load_dwordx4 v[204:207], v2, s[24:27], s55 offen offset:2048
    s_add_u32 s54, s54, 88064
    s_add_u32 s53, s53, 2048
    s_add_u32 s55, s55, 3072
    s_add_u32 m0, s40, 16384
    s_add_u32 s50, s54, 0
    buffer_load_dwordx4 v3, s[16:19], s50 offen lds
    s_add_u32 m0, s40, 17408
    s_add_u32 s50, s54, 44032
    buffer_load_dwordx4 v3, s[16:19], s50 offen lds
    s_add_u32 m0, s40, 18432
    s_add_u32 s50, s53, 0
    buffer_load_dwordx4 v153, s[24:27], s50 offen lds
    s_add_u32 m0, s40, 19456
    s_add_u32 s50, s53, 1024
    buffer_load_dwordx4 v153, s[24:27], s50 offen lds
    buffer_load_dwordx4 v[208:211], v2, s[24:27], s55 offen offset:0
    buffer_load_dwordx4 v[212:215], v2, s[24:27], s55 offen offset:1024
    buffer_load_dwordx4 v[216:219], v2, s[24:27], s55 offen offset:2048
    s_add_u32 s54, s54, 88064
    s_add_u32 s53, s53, 2048
    s_add_u32 s55, s55, 3072
    s_mov_b32 s28, s10
    s_and_b32 s29, s11, 0xffff
    s_mov_b32 s30, 0xac0
    s_mov_b32 s31, 0x00020000
    v_bfe_u32 v4, v1, 2, 2
    v_lshrrev_b32 v5, 4, v1
    v_lshl_add_u32 v4, v5, 2, v4
    v_bfe_u32 v5, v4, 1, 2
    v_lshlrev_b32 v5, 5, v5
    v_lshl_add_u32 v5, v4, 7, v5
    v_and_b32 v4, 3, v1
    v_lshl_add_u32 v5, v4, 3, v5
    v_add_u32 v140, s40, v5
    v_xor_b32 v141, 32, v140
    v_xor_b32 v142, 64, v140
    v_xor_b32 v143, 96, v140
    v_mov_b64 v[8:9], 0
    v_mov_b64 v[10:11], 0
    v_mov_b64 v[12:13], 0
    v_mov_b64 v[14:15], 0
    v_mov_b64 v[16:17], 0
    v_mov_b64 v[18:19], 0
    v_mov_b64 v[20:21], 0
    v_mov_b64 v[22:23], 0
    v_mov_b64 v[24:25], 0
    v_mov_b64 v[26:27], 0
    v_mov_b64 v[28:29], 0
    v_mov_b64 v[30:31], 0
    v_mov_b64 v[32:33], 0
    v_mov_b64 v[34:35], 0
    v_mov_b64 v[36:37], 0
    v_mov_b64 v[38:39], 0
    v_mov_b64 v[40:41], 0
    v_mov_b64 v[42:43], 0
    v_mov_b64 v[44:45], 0
    v_mov_b64 v[46:47], 0
    v_mov_b64 v[48:49], 0
    v_mov_b64 v[50:51], 0
    v_mov_b64 v[52:53], 0
    v_mov_b64 v[54:55], 0
    v_lshrrev_b32 v4, 4, v1
    v_lshlrev_b32 v5, 3, v4
    s_lshl_b32 s44, s38, 7
    s_lshl_b32 s45, s33, 5
    s_add_u32 s44, s44, s45
    buffer_load_dwordx2 v[146:147], v5, s[28:31], s44 offen
    v_and_b32 v6, 15, v1
    v_mul_u32_u24 v144, 272, v6
    v_lshl_add_u32 v145, v4, 4, v144
    s_lshl_b32 s45, s33, 6
    v_add_u32 v145, s45, v145
    v_lshl_add_u32 v144, v4, 4, v144
    s_mul_i32 s45, s33, 13056
    s_add_u32 s45, s45, 33792
    v_add_u32 v144, s45, v144
    v_add_u32 v145, 33792, v145
    s_mul_i32 s45, s39, 48
    s_min_u32 s45, s45, 464
    v_add_u32 v6, s45, v6
    v_lshrrev_b32 v7, 5, v1
    v_bfe_u32 v5, v1, 4, 1
    v_lshlrev_b32 v5, 3, v5
    v_lshl_add_u32 v5, v7, 9, v5
    s_mov_b32 s45, 176128
    v_add_u32 v7, 0, v6
    v_lshrrev_b32 v148, 6, v7
    v_mul_lo_u32 v148, v148, s45
    v_bfe_u32 v149, v7, 5, 1
    v_lshl_add_u32 v148, v149, 10, v148
    v_and_b32 v149, 31, v7
    v_lshl_add_u32 v148, v149, 4, v148
    v_add_u32 v150, v148, v5
    v_add_u32 v7, 16, v6
    v_lshrrev_b32 v148, 6, v7
    v_mul_lo_u32 v148, v148, s45
    v_bfe_u32 v149, v7, 5, 1
    v_lshl_add_u32 v148, v149, 10, v148
    v_and_b32 v149, 31, v7
    v_lshl_add_u32 v148, v149, 4, v148
    v_add_u32 v151, v148, v5
    v_add_u32 v7, 32, v6
    v_lshrrev_b32 v148, 6, v7
    v_mul_lo_u32 v148, v148, s45
    v_bfe_u32 v149, v7, 5, 1
    v_lshl_add_u32 v148, v149, 10, v148
    v_and_b32 v149, 31, v7
    v_lshl_add_u32 v148, v149, 4, v148
    v_add_u32 v152, v148, v5
    s_lshl_b32 s47, s38, 2
    s_add_u32 s47, s47, s33
    s_lshl_b32 s46, s47, 11
    s_add_u32 s46, s46, 17825792
    s_mov_b32 s48, 0xbdd2d3e8
    s_mov_b32 s49, 0xc0135761
    s_mov_b32 s44, 0
    s_waitcnt vmcnt(29)
    ds_read_b64_tr_b16 v[56:57], v140 offset:0
    ds_read_b64_tr_b16 v[58:59], v140 offset:2048
    ds_read_b64_tr_b16 v[60:61], v141 offset:0
    ds_read_b64_tr_b16 v[62:63], v141 offset:2048
    ds_read_b64_tr_b16 v[64:65], v142 offset:0
    ds_read_b64_tr_b16 v[66:67], v142 offset:2048
    ds_read_b64_tr_b16 v[68:69], v143 offset:0
    ds_read_b64_tr_b16 v[70:71], v143 offset:2048
K2_mloop:
    s_waitcnt vmcnt(21)
    ds_read_b64_tr_b16 v[72:73], v140 offset:4096
    ds_read_b64_tr_b16 v[74:75], v140 offset:6144
    ds_read_b64_tr_b16 v[76:77], v141 offset:4096
    ds_read_b64_tr_b16 v[78:79], v141 offset:6144
    ds_read_b64_tr_b16 v[80:81], v142 offset:4096
    ds_read_b64_tr_b16 v[82:83], v142 offset:6144
    ds_read_b64_tr_b16 v[84:85], v143 offset:4096
    ds_read_b64_tr_b16 v[86:87], v143 offset:6144
    s_waitcnt lgkmcnt(8)
    v_mfma_f32_16x16x32_bf16 v[8:11], v[56:59], v[160:163], v[8:11]
    s_add_u32 m0, s40, 20480
    s_add_u32 s50, s54, 0
    v_mfma_f32_16x16x32_bf16 v[12:15], v[56:59], v[164:167], v[12:15]
    buffer_load_dwordx4 v3, s[16:19], s50 offen lds
    s_add_u32 m0, s40, 21504
    v_mfma_f32_16x16x32_bf16 v[16:19], v[56:59], v[168:171], v[16:19]
    s_add_u32 s50, s54, 44032
    buffer_load_dwordx4 v3, s[16:19], s50 offen lds
    v_mfma_f32_16x16x32_bf16 v[20:23], v[60:63], v[160:163], v[20:23]
    s_add_u32 m0, s40, 22528
    s_add_u32 s50, s53, 0
    v_mfma_f32_16x16x32_bf16 v[24:27], v[60:63], v[164:167], v[24:27]
    buffer_load_dwordx4 v153, s[24:27], s50 offen lds
    s_add_u32 m0, s40, 23552
    v_mfma_f32_16x16x32_bf16 v[28:31], v[60:63], v[168:171], v[28:31]
    s_add_u32 s50, s53, 1024
    buffer_load_dwordx4 v153, s[24:27], s50 offen lds
    v_mfma_f32_16x16x32_bf16 v[32:35], v[64:67], v[160:163], v[32:35]
    buffer_load_dwordx4 v[220:223], v2, s[24:27], s55 offen offset:0
    buffer_load_dwordx4 v[224:227], v2, s[24:27], s55 offen offset:1024
    v_mfma_f32_16x16x32_bf16 v[36:39], v[64:67], v[164:167], v[36:39]
    buffer_load_dwordx4 v[228:231], v2, s[24:27], s55 offen offset:2048
    s_add_u32 s54, s54, 88064
    v_mfma_f32_16x16x32_bf16 v[40:43], v[64:67], v[168:171], v[40:43]
    s_add_u32 s53, s53, 2048
    s_add_u32 s55, s55, 3072
    v_mfma_f32_16x16x32_bf16 v[44:47], v[68:71], v[160:163], v[44:47]
    v_mfma_f32_16x16x32_bf16 v[48:51], v[68:71], v[164:167], v[48:51]
    v_mfma_f32_16x16x32_bf16 v[52:55], v[68:71], v[168:171], v[52:55]
    s_waitcnt vmcnt(21)
    ds_read_b64_tr_b16 v[56:57], v140 offset:8192
    ds_read_b64_tr_b16 v[58:59], v140 offset:10240
    ds_read_b64_tr_b16 v[60:61], v141 offset:8192
    ds_read_b64_tr_b16 v[62:63], v141 offset:10240
    ds_read_b64_tr_b16 v[64:65], v142 offset:8192
    ds_read_b64_tr_b16 v[66:67], v142 offset:10240
    ds_read_b64_tr_b16 v[68:69], v143 offset:8192
    ds_read_b64_tr_b16 v[70:71], v143 offset:10240
    s_waitcnt lgkmcnt(8)
    v_mfma_f32_16x16x32_bf16 v[8:11], v[72:75], v[172:175], v[8:11]
    s_add_u32 m0, s40, 0
    s_add_u32 s50, s54, 0
    v_mfma_f32_16x16x32_bf16 v[12:15], v[72:75], v[176:179], v[12:15]
    buffer_load_dwordx4 v3, s[16:19], s50 offen lds
    s_add_u32 m0, s40, 1024
    v_mfma_f32_16x16x32_bf16 v[16:19], v[72:75], v[180:183], v[16:19]
    s_add_u32 s50, s54, 44032
    buffer_load_dwordx4 v3, s[16:19], s50 offen lds
    v_mfma_f32_16x16x32_bf16 v[20:23], v[76:79], v[172:175], v[20:23]
    s_add_u32 m0, s40, 2048
    s_add_u32 s50, s53, 0
    v_mfma_f32_16x16x32_bf16 v[24:27], v[76:79], v[176:179], v[24:27]
    buffer_load_dwordx4 v153, s[24:27], s50 offen lds
    s_add_u32 m0, s40, 3072
    v_mfma_f32_16x16x32_bf16 v[28:31], v[76:79], v[180:183], v[28:31]
    s_add_u32 s50, s53, 1024
    buffer_load_dwordx4 v153, s[24:27], s50 offen lds
    v_mfma_f32_16x16x32_bf16 v[32:35], v[80:83], v[172:175], v[32:35]
    buffer_load_dwordx4 v[160:163], v2, s[24:27], s55 offen offset:0
    buffer_load_dwordx4 v[164:167], v2, s[24:27], s55 offen offset:1024
    v_mfma_f32_16x16x32_bf16 v[36:39], v[80:83], v[176:179], v[36:39]
    buffer_load_dwordx4 v[168:171], v2, s[24:27], s55 offen offset:2048
    s_add_u32 s54, s54, 88064
    v_mfma_f32_16x16x32_bf16 v[40:43], v[80:83], v[180:183], v[40:43]
    s_add_u32 s53, s53, 2048
    s_add_u32 s55, s55, 3072
    v_mfma_f32_16x16x32_bf16 v[44:47], v[84:87], v[172:175], v[44:47]
    v_mfma_f32_16x16x32_bf16 v[48:51], v[84:87], v[176:179], v[48:51]
    v_mfma_f32_16x16x32_bf16 v[52:55], v[84:87], v[180:183], v[52:55]
    s_waitcnt vmcnt(21)
    ds_read_b64_tr_b16 v[72:73], v140 offset:12288
    ds_read_b64_tr_b16 v[74:75], v140 offset:14336
    ds_read_b64_tr_b16 v[76:77], v141 offset:12288
    ds_read_b64_tr_b16 v[78:79], v141 offset:14336
    ds_read_b64_tr_b16 v[80:81], v142 offset:12288
    ds_read_b64_tr_b16 v[82:83], v142 offset:14336
    ds_read_b64_tr_b16 v[84:85], v143 offset:12288
    ds_read_b64_tr_b16 v[86:87], v143 offset:14336
    s_waitcnt lgkmcnt(8)
    v_mfma_f32_16x16x32_bf16 v[8:11], v[56:59], v[184:187], v[8:11]
    s_add_u32 m0, s40, 4096
    s_add_u32 s50, s54, 0
    v_mfma_f32_16x16x32_bf16 v[12:15], v[56:59], v[188:191], v[12:15]
    buffer_load_dwordx4 v3, s[16:19], s50 offen lds
    s_add_u32 m0, s40, 5120
    v_mfma_f32_16x16x32_bf16 v[16:19], v[56:59], v[192:195], v[16:19]
    s_add_u32 s50, s54, 44032
    buffer_load_dwordx4 v3, s[16:19], s50 offen lds
    v_mfma_f32_16x16x32_bf16 v[20:23], v[60:63], v[184:187], v[20:23]
    s_add_u32 m0, s40, 6144
    s_add_u32 s50, s53, 0
    v_mfma_f32_16x16x32_bf16 v[24:27], v[60:63], v[188:191], v[24:27]
    buffer_load_dwordx4 v153, s[24:27], s50 offen lds
    s_add_u32 m0, s40, 7168
    v_mfma_f32_16x16x32_bf16 v[28:31], v[60:63], v[192:195], v[28:31]
    s_add_u32 s50, s53, 1024
    buffer_load_dwordx4 v153, s[24:27], s50 offen lds
    v_mfma_f32_16x16x32_bf16 v[32:35], v[64:67], v[184:187], v[32:35]
    buffer_load_dwordx4 v[172:175], v2, s[24:27], s55 offen offset:0
    buffer_load_dwordx4 v[176:179], v2, s[24:27], s55 offen offset:1024
    v_mfma_f32_16x16x32_bf16 v[36:39], v[64:67], v[188:191], v[36:39]
    buffer_load_dwordx4 v[180:183], v2, s[24:27], s55 offen offset:2048
    s_add_u32 s54, s54, 88064
    v_mfma_f32_16x16x32_bf16 v[40:43], v[64:67], v[192:195], v[40:43]
    s_add_u32 s53, s53, 2048
    s_add_u32 s55, s55, 3072
    v_mfma_f32_16x16x32_bf16 v[44:47], v[68:71], v[184:187], v[44:47]
    v_mfma_f32_16x16x32_bf16 v[48:51], v[68:71], v[188:191], v[48:51]
    v_mfma_f32_16x16x32_bf16 v[52:55], v[68:71], v[192:195], v[52:55]
    s_waitcnt vmcnt(21)
    ds_read_b64_tr_b16 v[56:57], v140 offset:16384
    ds_read_b64_tr_b16 v[58:59], v140 offset:18432
    ds_read_b64_tr_b16 v[60:61], v141 offset:16384
    ds_read_b64_tr_b16 v[62:63], v141 offset:18432
    ds_read_b64_tr_b16 v[64:65], v142 offset:16384
    ds_read_b64_tr_b16 v[66:67], v142 offset:18432
    ds_read_b64_tr_b16 v[68:69], v143 offset:16384
    ds_read_b64_tr_b16 v[70:71], v143 offset:18432
    s_waitcnt lgkmcnt(8)
    v_mfma_f32_16x16x32_bf16 v[8:11], v[72:75], v[196:199], v[8:11]
    s_add_u32 m0, s40, 8192
    s_add_u32 s50, s54, 0
    v_mfma_f32_16x16x32_bf16 v[12:15], v[72:75], v[200:203], v[12:15]
    buffer_load_dwordx4 v3, s[16:19], s50 offen lds
    s_add_u32 m0, s40, 9216
    v_mfma_f32_16x16x32_bf16 v[16:19], v[72:75], v[204:207], v[16:19]
    s_add_u32 s50, s54, 44032
    buffer_load_dwordx4 v3, s[16:19], s50 offen lds
    v_mfma_f32_16x16x32_bf16 v[20:23], v[76:79], v[196:199], v[20:23]
    s_add_u32 m0, s40, 10240
    s_add_u32 s50, s53, 0
    v_mfma_f32_16x16x32_bf16 v[24:27], v[76:79], v[200:203], v[24:27]
    buffer_load_dwordx4 v153, s[24:27], s50 offen lds
    s_add_u32 m0, s40, 11264
    v_mfma_f32_16x16x32_bf16 v[28:31], v[76:79], v[204:207], v[28:31]
    s_add_u32 s50, s53, 1024
    buffer_load_dwordx4 v153, s[24:27], s50 offen lds
    v_mfma_f32_16x16x32_bf16 v[32:35], v[80:83], v[196:199], v[32:35]
    buffer_load_dwordx4 v[184:187], v2, s[24:27], s55 offen offset:0
    buffer_load_dwordx4 v[188:191], v2, s[24:27], s55 offen offset:1024
    v_mfma_f32_16x16x32_bf16 v[36:39], v[80:83], v[200:203], v[36:39]
    buffer_load_dwordx4 v[192:195], v2, s[24:27], s55 offen offset:2048
    s_add_u32 s54, s54, 88064
    v_mfma_f32_16x16x32_bf16 v[40:43], v[80:83], v[204:207], v[40:43]
    s_add_u32 s53, s53, 2048
    s_add_u32 s55, s55, 3072
    v_mfma_f32_16x16x32_bf16 v[44:47], v[84:87], v[196:199], v[44:47]
    v_mfma_f32_16x16x32_bf16 v[48:51], v[84:87], v[200:203], v[48:51]
    v_mfma_f32_16x16x32_bf16 v[52:55], v[84:87], v[204:207], v[52:55]
    s_waitcnt vmcnt(21)
    ds_read_b64_tr_b16 v[72:73], v140 offset:20480
    ds_read_b64_tr_b16 v[74:75], v140 offset:22528
    ds_read_b64_tr_b16 v[76:77], v141 offset:20480
    ds_read_b64_tr_b16 v[78:79], v141 offset:22528
    ds_read_b64_tr_b16 v[80:81], v142 offset:20480
    ds_read_b64_tr_b16 v[82:83], v142 offset:22528
    ds_read_b64_tr_b16 v[84:85], v143 offset:20480
    ds_read_b64_tr_b16 v[86:87], v143 offset:22528
    s_waitcnt lgkmcnt(8)
    v_mfma_f32_16x16x32_bf16 v[8:11], v[56:59], v[208:211], v[8:11]
    s_add_u32 m0, s40, 12288
    s_add_u32 s50, s54, 0
    v_mfma_f32_16x16x32_bf16 v[12:15], v[56:59], v[212:215], v[12:15]
    buffer_load_dwordx4 v3, s[16:19], s50 offen lds
    s_add_u32 m0, s40, 13312
    v_mfma_f32_16x16x32_bf16 v[16:19], v[56:59], v[216:219], v[16:19]
    s_add_u32 s50, s54, 44032
    buffer_load_dwordx4 v3, s[16:19], s50 offen lds
    v_mfma_f32_16x16x32_bf16 v[20:23], v[60:63], v[208:211], v[20:23]
    s_add_u32 m0, s40, 14336
    s_add_u32 s50, s53, 0
    v_mfma_f32_16x16x32_bf16 v[24:27], v[60:63], v[212:215], v[24:27]
    buffer_load_dwordx4 v153, s[24:27], s50 offen lds
    s_add_u32 m0, s40, 15360
    v_mfma_f32_16x16x32_bf16 v[28:31], v[60:63], v[216:219], v[28:31]
    s_add_u32 s50, s53, 1024
    buffer_load_dwordx4 v153, s[24:27], s50 offen lds
    v_mfma_f32_16x16x32_bf16 v[32:35], v[64:67], v[208:211], v[32:35]
    buffer_load_dwordx4 v[196:199], v2, s[24:27], s55 offen offset:0
    buffer_load_dwordx4 v[200:203], v2, s[24:27], s55 offen offset:1024
    v_mfma_f32_16x16x32_bf16 v[36:39], v[64:67], v[212:215], v[36:39]
    buffer_load_dwordx4 v[204:207], v2, s[24:27], s55 offen offset:2048
    s_add_u32 s54, s54, 88064
    v_mfma_f32_16x16x32_bf16 v[40:43], v[64:67], v[216:219], v[40:43]
    s_add_u32 s53, s53, 2048
    s_add_u32 s55, s55, 3072
    v_mfma_f32_16x16x32_bf16 v[44:47], v[68:71], v[208:211], v[44:47]
    v_mfma_f32_16x16x32_bf16 v[48:51], v[68:71], v[212:215], v[48:51]
    v_mfma_f32_16x16x32_bf16 v[52:55], v[68:71], v[216:219], v[52:55]
    s_waitcnt vmcnt(21)
    ds_read_b64_tr_b16 v[56:57], v140 offset:0
    ds_read_b64_tr_b16 v[58:59], v140 offset:2048
    ds_read_b64_tr_b16 v[60:61], v141 offset:0
    ds_read_b64_tr_b16 v[62:63], v141 offset:2048
    ds_read_b64_tr_b16 v[64:65], v142 offset:0
    ds_read_b64_tr_b16 v[66:67], v142 offset:2048
    ds_read_b64_tr_b16 v[68:69], v143 offset:0
    ds_read_b64_tr_b16 v[70:71], v143 offset:2048
    s_waitcnt lgkmcnt(8)
    v_mfma_f32_16x16x32_bf16 v[8:11], v[72:75], v[220:223], v[8:11]
    v_mfma_f32_16x16x32_bf16 v[12:15], v[72:75], v[224:227], v[12:15]
    v_mfma_f32_16x16x32_bf16 v[16:19], v[72:75], v[228:231], v[16:19]
    v_mfma_f32_16x16x32_bf16 v[20:23], v[76:79], v[220:223], v[20:23]
    s_cmp_eq_u32 s44, 1
    s_cbranch_scc1 K2_msk
    s_add_u32 m0, s40, 16384
    s_add_u32 s50, s54, 0
    buffer_load_dwordx4 v3, s[16:19], s50 offen lds
    s_add_u32 m0, s40, 17408
    s_add_u32 s50, s54, 44032
    buffer_load_dwordx4 v3, s[16:19], s50 offen lds
    s_add_u32 m0, s40, 18432
    s_add_u32 s50, s53, 0
    buffer_load_dwordx4 v153, s[24:27], s50 offen lds
    s_add_u32 m0, s40, 19456
    s_add_u32 s50, s53, 1024
    buffer_load_dwordx4 v153, s[24:27], s50 offen lds
    buffer_load_dwordx4 v[208:211], v2, s[24:27], s55 offen offset:0
    buffer_load_dwordx4 v[212:215], v2, s[24:27], s55 offen offset:1024
    buffer_load_dwordx4 v[216:219], v2, s[24:27], s55 offen offset:2048
    s_add_u32 s54, s54, 88064
    s_add_u32 s53, s53, 2048
    s_add_u32 s55, s55, 3072
K2_msk:
    v_mfma_f32_16x16x32_bf16 v[24:27], v[76:79], v[224:227], v[24:27]
    v_mfma_f32_16x16x32_bf16 v[28:31], v[76:79], v[228:231], v[28:31]
    v_mfma_f32_16x16x32_bf16 v[32:35], v[80:83], v[220:223], v[32:35]
    v_mfma_f32_16x16x32_bf16 v[36:39], v[80:83], v[224:227], v[36:39]
    v_mfma_f32_16x16x32_bf16 v[40:43], v[80:83], v[228:231], v[40:43]
    v_mfma_f32_16x16x32_bf16 v[44:47], v[84:87], v[220:223], v[44:47]
    v_mfma_f32_16x16x32_bf16 v[48:51], v[84:87], v[224:227], v[48:51]
    v_mfma_f32_16x16x32_bf16 v[52:55], v[84:87], v[228:231], v[52:55]
    s_add_u32 s44, s44, 1
    s_cmp_lt_u32 s44, 2
    s_cbranch_scc1 K2_mloop
    s_waitcnt vmcnt(14)
    ds_read_b64_tr_b16 v[72:73], v140 offset:4096
    ds_read_b64_tr_b16 v[74:75], v140 offset:6144
    ds_read_b64_tr_b16 v[76:77], v141 offset:4096
    ds_read_b64_tr_b16 v[78:79], v141 offset:6144
    ds_read_b64_tr_b16 v[80:81], v142 offset:4096
    ds_read_b64_tr_b16 v[82:83], v142 offset:6144
    ds_read_b64_tr_b16 v[84:85], v143 offset:4096
    ds_read_b64_tr_b16 v[86:87], v143 offset:6144
    s_waitcnt lgkmcnt(8)
    v_mfma_f32_16x16x32_bf16 v[8:11], v[56:59], v[160:163], v[8:11]
    v_mfma_f32_16x16x32_bf16 v[12:15], v[56:59], v[164:167], v[12:15]
    v_mfma_f32_16x16x32_bf16 v[16:19], v[56:59], v[168:171], v[16:19]
    v_mfma_f32_16x16x32_bf16 v[20:23], v[60:63], v[160:163], v[20:23]
    v_mfma_f32_16x16x32_bf16 v[24:27], v[60:63], v[164:167], v[24:27]
    v_mfma_f32_16x16x32_bf16 v[28:31], v[60:63], v[168:171], v[28:31]
    v_mfma_f32_16x16x32_bf16 v[32:35], v[64:67], v[160:163], v[32:35]
    v_mfma_f32_16x16x32_bf16 v[36:39], v[64:67], v[164:167], v[36:39]
    v_mfma_f32_16x16x32_bf16 v[40:43], v[64:67], v[168:171], v[40:43]
    v_mfma_f32_16x16x32_bf16 v[44:47], v[68:71], v[160:163], v[44:47]
    v_mfma_f32_16x16x32_bf16 v[48:51], v[68:71], v[164:167], v[48:51]
    v_mfma_f32_16x16x32_bf16 v[52:55], v[68:71], v[168:171], v[52:55]
    s_waitcnt vmcnt(7)
    ds_read_b64_tr_b16 v[56:57], v140 offset:8192
    ds_read_b64_tr_b16 v[58:59], v140 offset:10240
    ds_read_b64_tr_b16 v[60:61], v141 offset:8192
    ds_read_b64_tr_b16 v[62:63], v141 offset:10240
    ds_read_b64_tr_b16 v[64:65], v142 offset:8192
    ds_read_b64_tr_b16 v[66:67], v142 offset:10240
    ds_read_b64_tr_b16 v[68:69], v143 offset:8192
    ds_read_b64_tr_b16 v[70:71], v143 offset:10240
    s_waitcnt lgkmcnt(8)
    v_mfma_f32_16x16x32_bf16 v[8:11], v[72:75], v[172:175], v[8:11]
    v_mfma_f32_16x16x32_bf16 v[12:15], v[72:75], v[176:179], v[12:15]
    v_mfma_f32_16x16x32_bf16 v[16:19], v[72:75], v[180:183], v[16:19]
    v_mfma_f32_16x16x32_bf16 v[20:23], v[76:79], v[172:175], v[20:23]
    v_mfma_f32_16x16x32_bf16 v[24:27], v[76:79], v[176:179], v[24:27]
    v_mfma_f32_16x16x32_bf16 v[28:31], v[76:79], v[180:183], v[28:31]
    v_mfma_f32_16x16x32_bf16 v[32:35], v[80:83], v[172:175], v[32:35]
    v_mfma_f32_16x16x32_bf16 v[36:39], v[80:83], v[176:179], v[36:39]
    v_mfma_f32_16x16x32_bf16 v[40:43], v[80:83], v[180:183], v[40:43]
    v_mfma_f32_16x16x32_bf16 v[44:47], v[84:87], v[172:175], v[44:47]
    v_mfma_f32_16x16x32_bf16 v[48:51], v[84:87], v[176:179], v[48:51]
    v_mfma_f32_16x16x32_bf16 v[52:55], v[84:87], v[180:183], v[52:55]
    s_waitcnt vmcnt(0)
    ds_read_b64_tr_b16 v[72:73], v140 offset:12288
    ds_read_b64_tr_b16 v[74:75], v140 offset:14336
    ds_read_b64_tr_b16 v[76:77], v141 offset:12288
    ds_read_b64_tr_b16 v[78:79], v141 offset:14336
    ds_read_b64_tr_b16 v[80:81], v142 offset:12288
    ds_read_b64_tr_b16 v[82:83], v142 offset:14336
    ds_read_b64_tr_b16 v[84:85], v143 offset:12288
    ds_read_b64_tr_b16 v[86:87], v143 offset:14336
    s_waitcnt lgkmcnt(8)
    v_mfma_f32_16x16x32_bf16 v[8:11], v[56:59], v[184:187], v[8:11]
    v_mfma_f32_16x16x32_bf16 v[12:15], v[56:59], v[188:191], v[12:15]
    v_mfma_f32_16x16x32_bf16 v[16:19], v[56:59], v[192:195], v[16:19]
    v_mfma_f32_16x16x32_bf16 v[20:23], v[60:63], v[184:187], v[20:23]
    v_mfma_f32_16x16x32_bf16 v[24:27], v[60:63], v[188:191], v[24:27]
    v_mfma_f32_16x16x32_bf16 v[28:31], v[60:63], v[192:195], v[28:31]
    v_mfma_f32_16x16x32_bf16 v[32:35], v[64:67], v[184:187], v[32:35]
    v_mfma_f32_16x16x32_bf16 v[36:39], v[64:67], v[188:191], v[36:39]
    v_mfma_f32_16x16x32_bf16 v[40:43], v[64:67], v[192:195], v[40:43]
    v_mfma_f32_16x16x32_bf16 v[44:47], v[68:71], v[184:187], v[44:47]
    v_mfma_f32_16x16x32_bf16 v[48:51], v[68:71], v[188:191], v[48:51]
    v_mfma_f32_16x16x32_bf16 v[52:55], v[68:71], v[192:195], v[52:55]
    s_waitcnt lgkmcnt(0)
    v_mfma_f32_16x16x32_bf16 v[8:11], v[72:75], v[196:199], v[8:11]
    v_mfma_f32_16x16x32_bf16 v[12:15], v[72:75], v[200:203], v[12:15]
    v_mfma_f32_16x16x32_bf16 v[16:19], v[72:75], v[204:207], v[16:19]
    v_mfma_f32_16x16x32_bf16 v[20:23], v[76:79], v[196:199], v[20:23]
    v_mfma_f32_16x16x32_bf16 v[24:27], v[76:79], v[200:203], v[24:27]
    v_mfma_f32_16x16x32_bf16 v[28:31], v[76:79], v[204:207], v[28:31]
    v_mfma_f32_16x16x32_bf16 v[32:35], v[80:83], v[196:199], v[32:35]
    v_mfma_f32_16x16x32_bf16 v[36:39], v[80:83], v[200:203], v[36:39]
    v_mfma_f32_16x16x32_bf16 v[40:43], v[80:83], v[204:207], v[40:43]
    v_mfma_f32_16x16x32_bf16 v[44:47], v[84:87], v[196:199], v[44:47]
    v_mfma_f32_16x16x32_bf16 v[48:51], v[84:87], v[200:203], v[48:51]
    v_mfma_f32_16x16x32_bf16 v[52:55], v[84:87], v[204:207], v[52:55]
    s_mul_i32 s44, s38, 11
    s_add_u32 s44, s44, s39
    s_mul_i32 s45, s33, 242
    s_add_u32 s44, s44, s45
    s_cmp_lt_u32 s44, 480
    s_cbranch_scc0 K2_np
    s_mul_i32 s45, s44, 683
    s_lshr_b32 s45, s45, 11
    s_mul_i32 s50, s45, 3
    s_sub_u32 s50, s44, s50
    s_mul_i32 s50, s50, 232
    s_add_u32 s50, s50, s45
    s_add_u32 s50, s50, 72
    s_lshl_b32 s50, s50, 13
    s_mov_b32 s16, s6
    s_and_b32 s17, s7, 0xffff
    s_mov_b32 s18, 0x560000
    s_mov_b32 s19, 0x00020000
    v_lshlrev_b32 v154, 7, v1
    buffer_load_dword v155, v154, s[16:19], s50 offen
K2_np:
    v_mov_b32 v4, 33284
    v_mov_b32 v5, 1
    s_mov_b64 exec, 1
    ds_add_u32 v4, v5
    s_mov_b64 exec, -1
K2_sy1:
    ds_read_b32 v5, v4
    s_waitcnt lgkmcnt(0)
    v_readfirstlane_b32 s68, v5
    s_cmp_ge_u32 s68, 4
    s_cbranch_scc0 K2_sy1
    ds_write_b128 v144, v[8:11] offset:0
    ds_write_b128 v144, v[12:15] offset:4352
    ds_write_b128 v144, v[16:19] offset:8704
    ds_write_b128 v144, v[20:23] offset:64
    ds_write_b128 v144, v[24:27] offset:4416
    ds_write_b128 v144, v[28:31] offset:8768
    ds_write_b128 v144, v[32:35] offset:128
    ds_write_b128 v144, v[36:39] offset:4480
    ds_write_b128 v144, v[40:43] offset:8832
    ds_write_b128 v144, v[44:47] offset:192
    ds_write_b128 v144, v[48:51] offset:4544
    ds_write_b128 v144, v[52:55] offset:8896
    v_lshlrev_b32 v136, 16, v146
    v_and_b32 v137, 0xffff0000, v146
    v_lshlrev_b32 v138, 16, v147
    v_and_b32 v139, 0xffff0000, v147
    s_waitcnt lgkmcnt(0)
    v_mov_b32 v4, 33288
    v_mov_b32 v5, 1
    s_mov_b64 exec, 1
    ds_add_u32 v4, v5
    s_mov_b64 exec, -1
K2_sy2:
    ds_read_b32 v5, v4
    s_waitcnt lgkmcnt(0)
    v_readfirstlane_b32 s68, v5
    s_cmp_ge_u32 s68, 4
    s_cbranch_scc0 K2_sy2
    s_cmp_ge_u32 s47, 86
    s_cbranch_scc1 K2_mdone
    ds_read_b128 v[56:59], v145 offset:0
    ds_read_b128 v[60:63], v145 offset:13056
    ds_read_b128 v[64:67], v145 offset:26112
    ds_read_b128 v[68:71], v145 offset:39168
    ds_read_b128 v[72:75], v145 offset:4352
    ds_read_b128 v[76:79], v145 offset:17408
    ds_read_b128 v[80:83], v145 offset:30464
    ds_read_b128 v[84:87], v145 offset:43520
    ds_read_b128 v[88:91], v145 offset:8704
    ds_read_b128 v[92:95], v145 offset:21760
    ds_read_b128 v[96:99], v145 offset:34816
    ds_read_b128 v[100:103], v145 offset:47872
    s_waitcnt lgkmcnt(8)
    v_pk_add_f32 v[56:57], v[56:57], v[60:61]
    v_pk_add_f32 v[58:59], v[58:59], v[62:63]
    v_pk_add_f32 v[64:65], v[64:65], v[68:69]
    v_pk_add_f32 v[66:67], v[66:67], v[70:71]
    v_pk_add_f32 v[56:57], v[56:57], v[136:137]
    v_pk_add_f32 v[58:59], v[58:59], v[138:139]
    v_pk_add_f32 v[56:57], v[56:57], v[64:65]
    v_pk_add_f32 v[58:59], v[58:59], v[66:67]
    v_pk_mul_f32 v[64:65], v[56:57], v[56:57]
    v_pk_mul_f32 v[66:67], v[58:59], v[58:59]
    v_mov_b32 v68, s49
    v_mov_b32 v69, s49
    v_mov_b32 v70, s49
    v_mov_b32 v71, s49
    v_fmac_f32 v68, s48, v64
    v_fmac_f32 v69, s48, v65
    v_fmac_f32 v70, s48, v66
    v_fmac_f32 v71, s48, v67
    v_pk_mul_f32 v[64:65], v[56:57], v[68:69]
    v_pk_mul_f32 v[66:67], v[58:59], v[70:71]
    v_exp_f32 v64, v64
    v_exp_f32 v65, v65
    v_exp_f32 v66, v66
    v_exp_f32 v67, v67
    v_add_f32 v64, 1.0, v64
    v_add_f32 v65, 1.0, v65
    v_add_f32 v66, 1.0, v66
    v_add_f32 v67, 1.0, v67
    v_rcp_f32 v64, v64
    v_rcp_f32 v65, v65
    v_rcp_f32 v66, v66
    v_rcp_f32 v67, v67
    s_nop 0
    v_pk_mul_f32 v[56:57], v[56:57], v[64:65]
    v_pk_mul_f32 v[58:59], v[58:59], v[66:67]
    v_cvt_pk_bf16_f32 v60, v56, v57
    v_cvt_pk_bf16_f32 v61, v58, v59
    buffer_store_dwordx2 v[60:61], v150, s[24:27], s46 offen sc1
    s_waitcnt lgkmcnt(4)
    v_pk_add_f32 v[72:73], v[72:73], v[76:77]
    v_pk_add_f32 v[74:75], v[74:75], v[78:79]
    v_pk_add_f32 v[80:81], v[80:81], v[84:85]
    v_pk_add_f32 v[82:83], v[82:83], v[86:87]
    v_pk_add_f32 v[72:73], v[72:73], v[136:137]
    v_pk_add_f32 v[74:75], v[74:75], v[138:139]
    v_pk_add_f32 v[72:73], v[72:73], v[80:81]
    v_pk_add_f32 v[74:75], v[74:75], v[82:83]
    v_pk_mul_f32 v[80:81], v[72:73], v[72:73]
    v_pk_mul_f32 v[82:83], v[74:75], v[74:75]
    v_mov_b32 v84, s49
    v_mov_b32 v85, s49
    v_mov_b32 v86, s49
    v_mov_b32 v87, s49
    v_fmac_f32 v84, s48, v80
    v_fmac_f32 v85, s48, v81
    v_fmac_f32 v86, s48, v82
    v_fmac_f32 v87, s48, v83
    v_pk_mul_f32 v[80:81], v[72:73], v[84:85]
    v_pk_mul_f32 v[82:83], v[74:75], v[86:87]
    v_exp_f32 v80, v80
    v_exp_f32 v81, v81
    v_exp_f32 v82, v82
    v_exp_f32 v83, v83
    v_add_f32 v80, 1.0, v80
    v_add_f32 v81, 1.0, v81
    v_add_f32 v82, 1.0, v82
    v_add_f32 v83, 1.0, v83
    v_rcp_f32 v80, v80
    v_rcp_f32 v81, v81
    v_rcp_f32 v82, v82
    v_rcp_f32 v83, v83
    s_nop 0
    v_pk_mul_f32 v[72:73], v[72:73], v[80:81]
    v_pk_mul_f32 v[74:75], v[74:75], v[82:83]
    v_cvt_pk_bf16_f32 v76, v72, v73
    v_cvt_pk_bf16_f32 v77, v74, v75
    buffer_store_dwordx2 v[76:77], v151, s[24:27], s46 offen sc1
    s_waitcnt lgkmcnt(0)
    v_pk_add_f32 v[88:89], v[88:89], v[92:93]
    v_pk_add_f32 v[90:91], v[90:91], v[94:95]
    v_pk_add_f32 v[96:97], v[96:97], v[100:101]
    v_pk_add_f32 v[98:99], v[98:99], v[102:103]
    v_pk_add_f32 v[88:89], v[88:89], v[136:137]
    v_pk_add_f32 v[90:91], v[90:91], v[138:139]
    v_pk_add_f32 v[88:89], v[88:89], v[96:97]
    v_pk_add_f32 v[90:91], v[90:91], v[98:99]
    v_pk_mul_f32 v[96:97], v[88:89], v[88:89]
    v_pk_mul_f32 v[98:99], v[90:91], v[90:91]
    v_mov_b32 v100, s49
    v_mov_b32 v101, s49
    v_mov_b32 v102, s49
    v_mov_b32 v103, s49
    v_fmac_f32 v100, s48, v96
    v_fmac_f32 v101, s48, v97
    v_fmac_f32 v102, s48, v98
    v_fmac_f32 v103, s48, v99
    v_pk_mul_f32 v[96:97], v[88:89], v[100:101]
    v_pk_mul_f32 v[98:99], v[90:91], v[102:103]
    v_exp_f32 v96, v96
    v_exp_f32 v97, v97
    v_exp_f32 v98, v98
    v_exp_f32 v99, v99
    v_add_f32 v96, 1.0, v96
    v_add_f32 v97, 1.0, v97
    v_add_f32 v98, 1.0, v98
    v_add_f32 v99, 1.0, v99
    v_rcp_f32 v96, v96
    v_rcp_f32 v97, v97
    v_rcp_f32 v98, v98
    v_rcp_f32 v99, v99
    s_nop 0
    v_pk_mul_f32 v[88:89], v[88:89], v[96:97]
    v_pk_mul_f32 v[90:91], v[90:91], v[98:99]
    v_cvt_pk_bf16_f32 v92, v88, v89
    v_cvt_pk_bf16_f32 v93, v90, v91
    buffer_store_dwordx2 v[92:93], v152, s[24:27], s46 offen sc1
K2_mdone:
    s_endpgm
K2_pref:
    s_lshl_b32 s36, s34, 1
    s_add_u32 s36, s36, s35
    s_sub_u32 s36, s36, 30
    s_lshl_b32 s36, s36, 2
    s_add_u32 s36, s36, s33
    v_lshlrev_b32 v4, 7, v1
    s_waitcnt lgkmcnt(0)
    s_mov_b32 s16, s6
    s_and_b32 s17, s7, 0xffff
    s_mov_b32 s18, 0x560000
    s_mov_b32 s19, 0x00020000
    s_mov_b32 s20, s4
    s_and_b32 s21, s5, 0xffff
    s_mov_b32 s22, 0x80000
    s_mov_b32 s23, 0x00020000
K2_pf1:
    s_cmp_lt_u32 s36, 64
    s_cbranch_scc0 K2_pf2
    s_lshl_b32 s39, s36, 13
    buffer_load_dword v8, v4, s[20:23], s39 offen
    s_add_u32 s36, s36, 56
    s_branch K2_pf1
K2_pf2:
    s_sub_u32 s37, s36, 64
    s_mul_i32 s38, s37, 171
    s_lshr_b32 s38, s38, 9
    s_mul_i32 s39, s38, 3
    s_sub_u32 s39, s37, s39
    s_mul_i32 s39, s39, 232
    s_add_u32 s39, s39, s38
    s_lshl_b32 s39, s39, 13
    buffer_load_dword v8, v4, s[16:19], s39 offen
    s_add_u32 s36, s36, 56
    s_cmp_lt_u32 s36, 280
    s_cbranch_scc1 K2_pf2
    s_endpgm
K2_attn:
    s_setprio 3
    s_lshl_b32 s36, s34, 2
    s_and_b32 s37, s35, 3
    s_add_u32 s36, s36, s37
    s_lshr_b32 s37, s35, 2
    s_lshl_b32 s38, s36, 16
    s_add_u32 s39, s38, 2097152
    s_add_u32 s40, s38, 4194304
    s_lshl_b32 s41, s37, 3
    s_add_u32 s41, s41, s33
    s_lshl_b32 s42, s41, 10
    s_add_u32 s42, s42, s38
    s_add_u32 s43, s42, 4096
    s_lshl_b32 s44, s37, 3
    s_lshl_b32 s45, s33, 2
    s_add_u32 s44, s44, s45
    s_sub_u32 s44, s44, 8
    v_lshrrev_b32 v3, 5, v1
    v_lshlrev_b32 v200, 9, v3
    s_lshl_b32 s45, s33, 12
    s_mul_i32 s46, s33, 4224
    s_add_u32 s46, s46, 16384
    v_mov_b32 v203, s46
    s_lshl_b32 s50, s44, 10
    s_cmp_lt_i32 s44, 0
    s_cselect_b64 s[48:49], -1, 0
    s_cselect_b32 s51, 0, s50
    s_cselect_b32 s52, 0, 1024
    s_cselect_b32 s50, 1073741824, s50
    s_cselect_b32 s56, 0, 0x3f803f80
    v_cndmask_b32 v202, v2, v200, s[48:49]
    v_mov_b32 v204, s56
    v_mov_b32 v205, s56
    v_mov_b64 v[206:207], 0
    s_waitcnt lgkmcnt(0)
    s_add_u32 s16, s12, s39
    s_addc_u32 s17, s13, 0
    s_and_b32 s17, s17, 0xffff
    s_mov_b32 s18, 0x10000
    s_mov_b32 s19, 0x00020000
    s_add_u32 s20, s12, s40
    s_addc_u32 s21, s13, 0
    s_and_b32 s21, s21, 0xffff
    s_mov_b32 s22, 0x10000
    s_mov_b32 s23, 0x00020000
    s_mov_b32 s24, s12
    s_and_b32 s25, s13, 0xffff
    s_mov_b32 s26, 0x1300000
    s_mov_b32 s27, 0x00020000
    buffer_load_dwordx4 v[4:7], v2, s[24:27], s42 offen
    s_add_u32 m0, s45, 0
    s_nop 0
    buffer_load_dwordx4 v202, s[16:19], s51 offen lds
    s_add_u32 m0, s46, 0
    s_add_u32 s51, s51, s52
    buffer_load_dwordx4 v2, s[20:23], s50 offen lds
    s_add_u32 s50, s50, 1024
    ds_write_b64 v203, v[204:205] offset:1024
    ds_write_b64 v203, v[204:205] offset:1032
    ds_write_b64 v203, v[206:207] offset:1040
    ds_write_b64 v203, v[206:207] offset:1048
    s_add_u32 m0, s45, 1024
    s_nop 0
    buffer_load_dwordx4 v202, s[16:19], s51 offen lds
    s_add_u32 m0, s46, 1056
    s_add_u32 s51, s51, s52
    buffer_load_dwordx4 v2, s[20:23], s50 offen lds
    s_add_u32 s50, s50, 1024
    ds_write_b64 v203, v[204:205] offset:2080
    ds_write_b64 v203, v[204:205] offset:2088
    ds_write_b64 v203, v[206:207] offset:2096
    ds_write_b64 v203, v[206:207] offset:2104
    s_add_u32 m0, s45, 2048
    s_nop 0
    buffer_load_dwordx4 v202, s[16:19], s51 offen lds
    s_add_u32 m0, s46, 2112
    s_add_u32 s51, s51, s52
    buffer_load_dwordx4 v2, s[20:23], s50 offen lds
    s_add_u32 s50, s50, 1024
    ds_write_b64 v203, v[204:205] offset:3136
    ds_write_b64 v203, v[204:205] offset:3144
    ds_write_b64 v203, v[206:207] offset:3152
    ds_write_b64 v203, v[206:207] offset:3160
    s_add_u32 m0, s45, 3072
    s_nop 0
    buffer_load_dwordx4 v202, s[16:19], s51 offen lds
    s_add_u32 m0, s46, 3168
    s_add_u32 s51, s51, s52
    buffer_load_dwordx4 v2, s[20:23], s50 offen lds
    s_add_u32 s50, s50, 1024
    ds_write_b64 v203, v[204:205] offset:4192
    ds_write_b64 v203, v[204:205] offset:4200
    ds_write_b64 v203, v[206:207] offset:4208
    ds_write_b64 v203, v[206:207] offset:4216
    buffer_load_dwordx4 v[208:211], v2, s[24:27], s43 offen
    s_setprio 0
    v_and_b32 v200, 31, v1
    v_lshlrev_b32 v201, 2, v3
    v_sub_u32 v200, v200, v201
    v_mov_b32 v201, 0xf149f2ca
    v_mov_b32 v202, 0
    v_cmp_le_i32 s[56:57], 0, v200
    v_cmp_le_i32 s[58:59], 1, v200
    v_cmp_le_i32 s[60:61], 2, v200
    v_cmp_le_i32 s[62:63], 3, v200
    v_cndmask_b32 v112, v201, v202, s[56:57]
    v_cndmask_b32 v96, v202, v201, s[56:57]
    v_cndmask_b32 v113, v201, v202, s[58:59]
    v_cndmask_b32 v97, v202, v201, s[58:59]
    v_cndmask_b32 v114, v201, v202, s[60:61]
    v_cndmask_b32 v98, v202, v201, s[60:61]
    v_cndmask_b32 v115, v201, v202, s[62:63]
    v_cndmask_b32 v99, v202, v201, s[62:63]
    v_cmp_le_i32 s[56:57], 8, v200
    v_cmp_le_i32 s[58:59], 9, v200
    v_cmp_le_i32 s[60:61], 10, v200
    v_cmp_le_i32 s[62:63], 11, v200
    v_cndmask_b32 v116, v201, v202, s[56:57]
    v_cndmask_b32 v100, v202, v201, s[56:57]
    v_cndmask_b32 v117, v201, v202, s[58:59]
    v_cndmask_b32 v101, v202, v201, s[58:59]
    v_cndmask_b32 v118, v201, v202, s[60:61]
    v_cndmask_b32 v102, v202, v201, s[60:61]
    v_cndmask_b32 v119, v201, v202, s[62:63]
    v_cndmask_b32 v103, v202, v201, s[62:63]
    v_cmp_le_i32 s[56:57], 16, v200
    v_cmp_le_i32 s[58:59], 17, v200
    v_cmp_le_i32 s[60:61], 18, v200
    v_cmp_le_i32 s[62:63], 19, v200
    v_cndmask_b32 v120, v201, v202, s[56:57]
    v_cndmask_b32 v104, v202, v201, s[56:57]
    v_cndmask_b32 v121, v201, v202, s[58:59]
    v_cndmask_b32 v105, v202, v201, s[58:59]
    v_cndmask_b32 v122, v201, v202, s[60:61]
    v_cndmask_b32 v106, v202, v201, s[60:61]
    v_cndmask_b32 v123, v201, v202, s[62:63]
    v_cndmask_b32 v107, v202, v201, s[62:63]
    v_cmp_le_i32 s[56:57], 24, v200
    v_cmp_le_i32 s[58:59], 25, v200
    v_cmp_le_i32 s[60:61], 26, v200
    v_cmp_le_i32 s[62:63], 27, v200
    v_cndmask_b32 v124, v201, v202, s[56:57]
    v_cndmask_b32 v108, v202, v201, s[56:57]
    v_cndmask_b32 v125, v201, v202, s[58:59]
    v_cndmask_b32 v109, v202, v201, s[58:59]
    v_cndmask_b32 v126, v201, v202, s[60:61]
    v_cndmask_b32 v110, v202, v201, s[60:61]
    v_cndmask_b32 v127, v201, v202, s[62:63]
    v_cndmask_b32 v111, v202, v201, s[62:63]
    s_lshl_b32 s45, s33, 10
    v_add_u32 v200, s45, v2
    s_mul_i32 s45, s33, 1056
    s_add_u32 s45, s45, 16384
    v_and_b32 v204, 15, v1
    v_lshlrev_b32 v204, 4, v204
    v_lshl_add_u32 v204, v3, 8, v204
    v_add_u32 v204, s45, v204
    v_add_u32 v205, 512, v204
    v_bfe_u32 v206, v1, 4, 1
    v_cmp_eq_u32 vcc, 1, v206
    s_add_u32 s45, s45, 1024
    v_mov_b32 v206, s45
    v_and_b32 v207, 11, v1
    v_cmp_ne_u32 s[56:57], 0, v207
    v_add_u32 v207, 16, v206
    s_nop 0
    v_cndmask_b32 v206, v206, v207, s[56:57]
    s_lshr_b32 s45, s41, 1
    v_cndmask_b32 v204, v204, v206, vcc
    v_cndmask_b32 v205, v205, v206, vcc
    s_lshl_b32 s45, s45, 16
    s_lshl_b32 s46, s36, 11
    s_add_u32 s45, s45, s46
    s_and_b32 s46, s41, 1
    s_lshl_b32 s46, s46, 10
    s_add_u32 s45, s45, s46
    s_add_u32 s45, s45, 15728640
    s_mov_b32 s47, 0
    s_waitcnt vmcnt(0) lgkmcnt(0)
    v_mov_b32 v202, 33280
    v_mov_b32 v203, 1
    s_mov_b64 exec, 1
    ds_add_u32 v202, v203
    s_mov_b64 exec, -1
K2_sy0:
    ds_read_b32 v203, v202
    s_waitcnt lgkmcnt(0)
    v_readfirstlane_b32 s68, v203
    s_cmp_ge_u32 s68, 4
    s_cbranch_scc0 K2_sy0
K2_aloop:
    ds_read_b128 v[8:11], v200 offset:0
    ds_read_b128 v[12:15], v200 offset:1024
    ds_read_b128 v[16:19], v200 offset:2048
    v_mov_b32 v202, 0xf149f2ca
    v_mov_b32 v203, 0xf149f2ca
    v_mov_b64 v[144:145], 0
    v_mov_b64 v[146:147], 0
    v_mov_b64 v[148:149], 0
    v_mov_b64 v[150:151], 0
    v_mov_b64 v[152:153], 0
    v_mov_b64 v[154:155], 0
    v_mov_b64 v[156:157], 0
    v_mov_b64 v[158:159], 0
    s_waitcnt lgkmcnt(2)
    v_mfma_f32_32x32x16_bf16 v[48:63], v[8:11], v[4:7], v[96:111]
    ds_read_b128 v[8:11], v200 offset:3072
    s_waitcnt lgkmcnt(2)
    v_mfma_f32_32x32x16_bf16 v[64:79], v[12:15], v[4:7], 0
    ds_read_b128 v[12:15], v200 offset:4096
    s_nop 7
    v_max3_f32 v202, v202, v48, v49
    v_max3_f32 v203, v203, v50, v51
    v_max3_f32 v202, v202, v52, v53
    v_max3_f32 v203, v203, v54, v55
    v_max3_f32 v202, v202, v56, v57
    v_max3_f32 v203, v203, v58, v59
    v_max3_f32 v202, v202, v60, v61
    v_max3_f32 v203, v203, v62, v63
    s_waitcnt lgkmcnt(2)
    v_mfma_f32_32x32x16_bf16 v[80:95], v[16:19], v[4:7], 0
    ds_read_b128 v[16:19], v200 offset:5120
    s_nop 1
    v_max3_f32 v202, v202, v64, v65
    v_max3_f32 v203, v203, v66, v67
    v_max3_f32 v202, v202, v68, v69
    v_max3_f32 v203, v203, v70, v71
    v_max3_f32 v202, v202, v72, v73
    v_max3_f32 v203, v203, v74, v75
    v_max3_f32 v202, v202, v76, v77
    v_max3_f32 v203, v203, v78, v79
    s_waitcnt lgkmcnt(2)
    v_mfma_f32_32x32x16_bf16 v[48:63], v[8:11], v[4:7], 0
    ds_read_b128 v[8:11], v200 offset:6144
    s_nop 1
    v_max3_f32 v202, v202, v80, v81
    v_max3_f32 v203, v203, v82, v83
    v_max3_f32 v202, v202, v84, v85
    v_max3_f32 v203, v203, v86, v87
    v_max3_f32 v202, v202, v88, v89
    v_max3_f32 v203, v203, v90, v91
    v_max3_f32 v202, v202, v92, v93
    v_max3_f32 v203, v203, v94, v95
    s_waitcnt lgkmcnt(2)
    v_mfma_f32_32x32x16_bf16 v[64:79], v[12:15], v[4:7], 0
    ds_read_b128 v[12:15], v200 offset:7168
    s_nop 1
    v_max3_f32 v202, v202, v48, v49
    v_max3_f32 v203, v203, v50, v51
    v_max3_f32 v202, v202, v52, v53
    v_max3_f32 v203, v203, v54, v55
    v_max3_f32 v202, v202, v56, v57
    v_max3_f32 v203, v203, v58, v59
    v_max3_f32 v202, v202, v60, v61
    v_max3_f32 v203, v203, v62, v63
    s_waitcnt lgkmcnt(2)
    v_mfma_f32_32x32x16_bf16 v[80:95], v[16:19], v[4:7], 0
    ds_read_b128 v[16:19], v200 offset:8192
    s_nop 1
    v_max3_f32 v202, v202, v64, v65
    v_max3_f32 v203, v203, v66, v67
    v_max3_f32 v202, v202, v68, v69
    v_max3_f32 v203, v203, v70, v71
    v_max3_f32 v202, v202, v72, v73
    v_max3_f32 v203, v203, v74, v75
    v_max3_f32 v202, v202, v76, v77
    v_max3_f32 v203, v203, v78, v79
    s_waitcnt lgkmcnt(2)
    v_mfma_f32_32x32x16_bf16 v[48:63], v[8:11], v[4:7], 0
    s_nop 1
    v_max3_f32 v202, v202, v80, v81
    v_max3_f32 v203, v203, v82, v83
    v_max3_f32 v202, v202, v84, v85
    v_max3_f32 v203, v203, v86, v87
    v_max3_f32 v202, v202, v88, v89
    v_max3_f32 v203, v203, v90, v91
    v_max3_f32 v202, v202, v92, v93
    v_max3_f32 v203, v203, v94, v95
    s_waitcnt lgkmcnt(1)
    v_mfma_f32_32x32x16_bf16 v[64:79], v[12:15], v[4:7], 0
    s_nop 1
    v_max3_f32 v202, v202, v48, v49
    v_max3_f32 v203, v203, v50, v51
    v_max3_f32 v202, v202, v52, v53
    v_max3_f32 v203, v203, v54, v55
    v_max3_f32 v202, v202, v56, v57
    v_max3_f32 v203, v203, v58, v59
    v_max3_f32 v202, v202, v60, v61
    v_max3_f32 v203, v203, v62, v63
    s_waitcnt lgkmcnt(0)
    v_mfma_f32_32x32x16_bf16 v[80:95], v[16:19], v[4:7], v[112:127]
    s_nop 1
    v_max3_f32 v202, v202, v64, v65
    v_max3_f32 v203, v203, v66, v67
    v_max3_f32 v202, v202, v68, v69
    v_max3_f32 v203, v203, v70, v71
    v_max3_f32 v202, v202, v72, v73
    v_max3_f32 v203, v203, v74, v75
    v_max3_f32 v202, v202, v76, v77
    v_max3_f32 v203, v203, v78, v79
    ds_read_b128 v[8:11], v200 offset:0
    ds_read_b128 v[12:15], v200 offset:1024
    ds_read_b128 v[16:19], v200 offset:2048
    s_nop 7
    v_max3_f32 v202, v202, v80, v81
    v_max3_f32 v203, v203, v82, v83
    v_max3_f32 v202, v202, v84, v85
    v_max3_f32 v203, v203, v86, v87
    v_max3_f32 v202, v202, v88, v89
    v_max3_f32 v203, v203, v90, v91
    v_max3_f32 v202, v202, v92, v93
    v_max3_f32 v203, v203, v94, v95
    v_max_f32 v202, v202, v203
    v_mov_b32 v203, v202
    s_nop 1
    v_permlane32_swap_b32 v202, v203
    v_max_f32 v202, v202, v203
    v_pk_add_f32 v[160:161], v[96:97], v[202:203] op_sel_hi:[1,0] neg_lo:[0,1] neg_hi:[0,1]
    v_pk_add_f32 v[162:163], v[98:99], v[202:203] op_sel_hi:[1,0] neg_lo:[0,1] neg_hi:[0,1]
    v_pk_add_f32 v[164:165], v[100:101], v[202:203] op_sel_hi:[1,0] neg_lo:[0,1] neg_hi:[0,1]
    v_pk_add_f32 v[166:167], v[102:103], v[202:203] op_sel_hi:[1,0] neg_lo:[0,1] neg_hi:[0,1]
    v_pk_add_f32 v[168:169], v[104:105], v[202:203] op_sel_hi:[1,0] neg_lo:[0,1] neg_hi:[0,1]
    v_pk_add_f32 v[170:171], v[106:107], v[202:203] op_sel_hi:[1,0] neg_lo:[0,1] neg_hi:[0,1]
    v_pk_add_f32 v[172:173], v[108:109], v[202:203] op_sel_hi:[1,0] neg_lo:[0,1] neg_hi:[0,1]
    v_pk_add_f32 v[174:175], v[110:111], v[202:203] op_sel_hi:[1,0] neg_lo:[0,1] neg_hi:[0,1]
    v_sub_f32 v128, 0, v202
    v_sub_f32 v129, 0, v202
    v_mov_b64 v[130:131], v[128:129]
    v_mov_b64 v[132:133], v[128:129]
    v_mov_b64 v[134:135], v[128:129]
    v_mov_b64 v[136:137], v[128:129]
    v_mov_b64 v[138:139], v[128:129]
    v_mov_b64 v[140:141], v[128:129]
    v_mov_b64 v[142:143], v[128:129]
    v_pk_add_f32 v[176:177], v[112:113], v[202:203] op_sel_hi:[1,0] neg_lo:[0,1] neg_hi:[0,1]
    v_pk_add_f32 v[178:179], v[114:115], v[202:203] op_sel_hi:[1,0] neg_lo:[0,1] neg_hi:[0,1]
    v_pk_add_f32 v[180:181], v[116:117], v[202:203] op_sel_hi:[1,0] neg_lo:[0,1] neg_hi:[0,1]
    v_pk_add_f32 v[182:183], v[118:119], v[202:203] op_sel_hi:[1,0] neg_lo:[0,1] neg_hi:[0,1]
    v_pk_add_f32 v[184:185], v[120:121], v[202:203] op_sel_hi:[1,0] neg_lo:[0,1] neg_hi:[0,1]
    v_pk_add_f32 v[186:187], v[122:123], v[202:203] op_sel_hi:[1,0] neg_lo:[0,1] neg_hi:[0,1]
    v_pk_add_f32 v[188:189], v[124:125], v[202:203] op_sel_hi:[1,0] neg_lo:[0,1] neg_hi:[0,1]
    v_pk_add_f32 v[190:191], v[126:127], v[202:203] op_sel_hi:[1,0] neg_lo:[0,1] neg_hi:[0,1]
    ds_read_b128 v[20:23], v204 offset:0
    ds_read_b128 v[24:27], v205 offset:0
    s_waitcnt lgkmcnt(4)
    v_mfma_f32_32x32x16_bf16 v[48:63], v[8:11], v[4:7], v[160:175]
    ds_read_b128 v[8:11], v200 offset:3072
    s_waitcnt lgkmcnt(4)
    v_mfma_f32_32x32x16_bf16 v[64:79], v[12:15], v[4:7], v[128:143]
    ds_read_b128 v[28:31], v204 offset:1056
    ds_read_b128 v[32:35], v205 offset:1056
    ds_read_b128 v[12:15], v200 offset:4096
    s_nop 7
    v_exp_f32 v48, v48
    v_exp_f32 v49, v49
    v_exp_f32 v50, v50
    v_exp_f32 v51, v51
    v_exp_f32 v52, v52
    v_exp_f32 v53, v53
    v_exp_f32 v54, v54
    v_exp_f32 v55, v55
    v_exp_f32 v56, v56
    v_exp_f32 v57, v57
    v_exp_f32 v58, v58
    v_exp_f32 v59, v59
    v_exp_f32 v60, v60
    v_exp_f32 v61, v61
    v_exp_f32 v62, v62
    v_exp_f32 v63, v63
    v_cvt_pk_bf16_f32 v36, v48, v49
    v_cvt_pk_bf16_f32 v37, v50, v51
    v_cvt_pk_bf16_f32 v38, v52, v53
    v_cvt_pk_bf16_f32 v39, v54, v55
    v_cvt_pk_bf16_f32 v40, v56, v57
    v_cvt_pk_bf16_f32 v41, v58, v59
    v_cvt_pk_bf16_f32 v42, v60, v61
    v_cvt_pk_bf16_f32 v43, v62, v63
    s_waitcnt lgkmcnt(4)
    s_nop 0
    v_mfma_f32_32x32x16_bf16 v[144:159], v[20:23], v[36:39], v[144:159]
    v_mfma_f32_32x32x16_bf16 v[144:159], v[24:27], v[40:43], v[144:159]
    s_waitcnt lgkmcnt(6)
    v_mfma_f32_32x32x16_bf16 v[48:63], v[16:19], v[4:7], v[128:143]
    ds_read_b128 v[20:23], v204 offset:2112
    ds_read_b128 v[24:27], v205 offset:2112
    ds_read_b128 v[16:19], v200 offset:5120
    v_exp_f32 v64, v64
    v_exp_f32 v65, v65
    v_exp_f32 v66, v66
    v_exp_f32 v67, v67
    v_exp_f32 v68, v68
    v_exp_f32 v69, v69
    v_exp_f32 v70, v70
    v_exp_f32 v71, v71
    v_exp_f32 v72, v72
    v_exp_f32 v73, v73
    v_exp_f32 v74, v74
    v_exp_f32 v75, v75
    v_exp_f32 v76, v76
    v_exp_f32 v77, v77
    v_exp_f32 v78, v78
    v_exp_f32 v79, v79
    v_cvt_pk_bf16_f32 v36, v64, v65
    v_cvt_pk_bf16_f32 v37, v66, v67
    v_cvt_pk_bf16_f32 v38, v68, v69
    v_cvt_pk_bf16_f32 v39, v70, v71
    v_cvt_pk_bf16_f32 v40, v72, v73
    v_cvt_pk_bf16_f32 v41, v74, v75
    v_cvt_pk_bf16_f32 v42, v76, v77
    v_cvt_pk_bf16_f32 v43, v78, v79
    s_waitcnt lgkmcnt(4)
    s_nop 0
    v_mfma_f32_32x32x16_bf16 v[144:159], v[28:31], v[36:39], v[144:159]
    v_mfma_f32_32x32x16_bf16 v[144:159], v[32:35], v[40:43], v[144:159]
    s_waitcnt lgkmcnt(6)
    v_mfma_f32_32x32x16_bf16 v[64:79], v[8:11], v[4:7], v[128:143]
    ds_read_b128 v[28:31], v204 offset:3168
    ds_read_b128 v[32:35], v205 offset:3168
    ds_read_b128 v[8:11], v200 offset:6144
    v_exp_f32 v48, v48
    v_exp_f32 v49, v49
    v_exp_f32 v50, v50
    v_exp_f32 v51, v51
    v_exp_f32 v52, v52
    v_exp_f32 v53, v53
    v_exp_f32 v54, v54
    v_exp_f32 v55, v55
    v_exp_f32 v56, v56
    v_exp_f32 v57, v57
    v_exp_f32 v58, v58
    v_exp_f32 v59, v59
    v_exp_f32 v60, v60
    v_exp_f32 v61, v61
    v_exp_f32 v62, v62
    v_exp_f32 v63, v63
    v_cvt_pk_bf16_f32 v36, v48, v49
    v_cvt_pk_bf16_f32 v37, v50, v51
    v_cvt_pk_bf16_f32 v38, v52, v53
    v_cvt_pk_bf16_f32 v39, v54, v55
    v_cvt_pk_bf16_f32 v40, v56, v57
    v_cvt_pk_bf16_f32 v41, v58, v59
    v_cvt_pk_bf16_f32 v42, v60, v61
    v_cvt_pk_bf16_f32 v43, v62, v63
    s_waitcnt lgkmcnt(4)
    s_nop 0
    v_mfma_f32_32x32x16_bf16 v[144:159], v[20:23], v[36:39], v[144:159]
    v_mfma_f32_32x32x16_bf16 v[144:159], v[24:27], v[40:43], v[144:159]
    s_waitcnt lgkmcnt(6)
    v_mfma_f32_32x32x16_bf16 v[48:63], v[12:15], v[4:7], v[128:143]
    ds_read_b128 v[20:23], v204 offset:4224
    ds_read_b128 v[24:27], v205 offset:4224
    ds_read_b128 v[12:15], v200 offset:7168
    v_exp_f32 v64, v64
    v_exp_f32 v65, v65
    v_exp_f32 v66, v66
    v_exp_f32 v67, v67
    v_exp_f32 v68, v68
    v_exp_f32 v69, v69
    v_exp_f32 v70, v70
    v_exp_f32 v71, v71
    v_exp_f32 v72, v72
    v_exp_f32 v73, v73
    v_exp_f32 v74, v74
    v_exp_f32 v75, v75
    v_exp_f32 v76, v76
    v_exp_f32 v77, v77
    v_exp_f32 v78, v78
    v_exp_f32 v79, v79
    v_cvt_pk_bf16_f32 v36, v64, v65
    v_cvt_pk_bf16_f32 v37, v66, v67
    v_cvt_pk_bf16_f32 v38, v68, v69
    v_cvt_pk_bf16_f32 v39, v70, v71
    v_cvt_pk_bf16_f32 v40, v72, v73
    v_cvt_pk_bf16_f32 v41, v74, v75
    v_cvt_pk_bf16_f32 v42, v76, v77
    v_cvt_pk_bf16_f32 v43, v78, v79
    s_waitcnt lgkmcnt(4)
    s_nop 0
    v_mfma_f32_32x32x16_bf16 v[144:159], v[28:31], v[36:39], v[144:159]
    v_mfma_f32_32x32x16_bf16 v[144:159], v[32:35], v[40:43], v[144:159]
    s_waitcnt lgkmcnt(6)
    v_mfma_f32_32x32x16_bf16 v[64:79], v[16:19], v[4:7], v[128:143]
    ds_read_b128 v[28:31], v204 offset:5280
    ds_read_b128 v[32:35], v205 offset:5280
    ds_read_b128 v[16:19], v200 offset:8192
    v_exp_f32 v48, v48
    v_exp_f32 v49, v49
    v_exp_f32 v50, v50
    v_exp_f32 v51, v51
    v_exp_f32 v52, v52
    v_exp_f32 v53, v53
    v_exp_f32 v54, v54
    v_exp_f32 v55, v55
    v_exp_f32 v56, v56
    v_exp_f32 v57, v57
    v_exp_f32 v58, v58
    v_exp_f32 v59, v59
    v_exp_f32 v60, v60
    v_exp_f32 v61, v61
    v_exp_f32 v62, v62
    v_exp_f32 v63, v63
    v_cvt_pk_bf16_f32 v36, v48, v49
    v_cvt_pk_bf16_f32 v37, v50, v51
    v_cvt_pk_bf16_f32 v38, v52, v53
    v_cvt_pk_bf16_f32 v39, v54, v55
    v_cvt_pk_bf16_f32 v40, v56, v57
    v_cvt_pk_bf16_f32 v41, v58, v59
    v_cvt_pk_bf16_f32 v42, v60, v61
    v_cvt_pk_bf16_f32 v43, v62, v63
    s_waitcnt lgkmcnt(4)
    s_nop 0
    v_mfma_f32_32x32x16_bf16 v[144:159], v[20:23], v[36:39], v[144:159]
    v_mfma_f32_32x32x16_bf16 v[144:159], v[24:27], v[40:43], v[144:159]
    s_waitcnt lgkmcnt(6)
    v_mfma_f32_32x32x16_bf16 v[48:63], v[8:11], v[4:7], v[128:143]
    ds_read_b128 v[20:23], v204 offset:6336
    ds_read_b128 v[24:27], v205 offset:6336
    v_exp_f32 v64, v64
    v_exp_f32 v65, v65
    v_exp_f32 v66, v66
    v_exp_f32 v67, v67
    v_exp_f32 v68, v68
    v_exp_f32 v69, v69
    v_exp_f32 v70, v70
    v_exp_f32 v71, v71
    v_exp_f32 v72, v72
    v_exp_f32 v73, v73
    v_exp_f32 v74, v74
    v_exp_f32 v75, v75
    v_exp_f32 v76, v76
    v_exp_f32 v77, v77
    v_exp_f32 v78, v78
    v_exp_f32 v79, v79
    v_cvt_pk_bf16_f32 v36, v64, v65
    v_cvt_pk_bf16_f32 v37, v66, v67
    v_cvt_pk_bf16_f32 v38, v68, v69
    v_cvt_pk_bf16_f32 v39, v70, v71
    v_cvt_pk_bf16_f32 v40, v72, v73
    v_cvt_pk_bf16_f32 v41, v74, v75
    v_cvt_pk_bf16_f32 v42, v76, v77
    v_cvt_pk_bf16_f32 v43, v78, v79
    s_waitcnt lgkmcnt(3)
    s_nop 0
    v_mfma_f32_32x32x16_bf16 v[144:159], v[28:31], v[36:39], v[144:159]
    v_mfma_f32_32x32x16_bf16 v[144:159], v[32:35], v[40:43], v[144:159]
    s_waitcnt lgkmcnt(5)
    v_mfma_f32_32x32x16_bf16 v[64:79], v[12:15], v[4:7], v[128:143]
    ds_read_b128 v[28:31], v204 offset:7392
    ds_read_b128 v[32:35], v205 offset:7392
    v_exp_f32 v48, v48
    v_exp_f32 v49, v49
    v_exp_f32 v50, v50
    v_exp_f32 v51, v51
    v_exp_f32 v52, v52
    v_exp_f32 v53, v53
    v_exp_f32 v54, v54
    v_exp_f32 v55, v55
    v_exp_f32 v56, v56
    v_exp_f32 v57, v57
    v_exp_f32 v58, v58
    v_exp_f32 v59, v59
    v_exp_f32 v60, v60
    v_exp_f32 v61, v61
    v_exp_f32 v62, v62
    v_exp_f32 v63, v63
    v_cvt_pk_bf16_f32 v36, v48, v49
    v_cvt_pk_bf16_f32 v37, v50, v51
    v_cvt_pk_bf16_f32 v38, v52, v53
    v_cvt_pk_bf16_f32 v39, v54, v55
    v_cvt_pk_bf16_f32 v40, v56, v57
    v_cvt_pk_bf16_f32 v41, v58, v59
    v_cvt_pk_bf16_f32 v42, v60, v61
    v_cvt_pk_bf16_f32 v43, v62, v63
    s_waitcnt lgkmcnt(2)
    s_nop 0
    v_mfma_f32_32x32x16_bf16 v[144:159], v[20:23], v[36:39], v[144:159]
    v_mfma_f32_32x32x16_bf16 v[144:159], v[24:27], v[40:43], v[144:159]
    s_waitcnt lgkmcnt(4)
    v_mfma_f32_32x32x16_bf16 v[48:63], v[16:19], v[4:7], v[176:191]
    ds_read_b128 v[20:23], v204 offset:8448
    ds_read_b128 v[24:27], v205 offset:8448
    v_exp_f32 v64, v64
    v_exp_f32 v65, v65
    v_exp_f32 v66, v66
    v_exp_f32 v67, v67
    v_exp_f32 v68, v68
    v_exp_f32 v69, v69
    v_exp_f32 v70, v70
    v_exp_f32 v71, v71
    v_exp_f32 v72, v72
    v_exp_f32 v73, v73
    v_exp_f32 v74, v74
    v_exp_f32 v75, v75
    v_exp_f32 v76, v76
    v_exp_f32 v77, v77
    v_exp_f32 v78, v78
    v_exp_f32 v79, v79
    v_cvt_pk_bf16_f32 v36, v64, v65
    v_cvt_pk_bf16_f32 v37, v66, v67
    v_cvt_pk_bf16_f32 v38, v68, v69
    v_cvt_pk_bf16_f32 v39, v70, v71
    v_cvt_pk_bf16_f32 v40, v72, v73
    v_cvt_pk_bf16_f32 v41, v74, v75
    v_cvt_pk_bf16_f32 v42, v76, v77
    v_cvt_pk_bf16_f32 v43, v78, v79
    s_waitcnt lgkmcnt(2)
    s_nop 0
    v_mfma_f32_32x32x16_bf16 v[144:159], v[28:31], v[36:39], v[144:159]
    v_mfma_f32_32x32x16_bf16 v[144:159], v[32:35], v[40:43], v[144:159]
    v_exp_f32 v48, v48
    v_exp_f32 v49, v49
    v_exp_f32 v50, v50
    v_exp_f32 v51, v51
    v_exp_f32 v52, v52
    v_exp_f32 v53, v53
    v_exp_f32 v54, v54
    v_exp_f32 v55, v55
    v_exp_f32 v56, v56
    v_exp_f32 v57, v57
    v_exp_f32 v58, v58
    v_exp_f32 v59, v59
    v_exp_f32 v60, v60
    v_exp_f32 v61, v61
    v_exp_f32 v62, v62
    v_exp_f32 v63, v63
    v_cvt_pk_bf16_f32 v36, v48, v49
    v_cvt_pk_bf16_f32 v37, v50, v51
    v_cvt_pk_bf16_f32 v38, v52, v53
    v_cvt_pk_bf16_f32 v39, v54, v55
    v_cvt_pk_bf16_f32 v40, v56, v57
    v_cvt_pk_bf16_f32 v41, v58, v59
    v_cvt_pk_bf16_f32 v42, v60, v61
    v_cvt_pk_bf16_f32 v43, v62, v63
    s_waitcnt lgkmcnt(0)
    s_nop 0
    v_mfma_f32_32x32x16_bf16 v[144:159], v[20:23], v[36:39], v[144:159]
    v_mfma_f32_32x32x16_bf16 v[144:159], v[24:27], v[40:43], v[144:159]
    v_add_u32 v200, 4096, v200
    v_add_u32 v204, 4224, v204
    v_add_u32 v205, 4224, v205
    v_mov_b64 v[4:5], v[208:209]
    v_mov_b64 v[6:7], v[210:211]
    s_nop 7
    v_rcp_f32 v202, v152
    s_nop 0
    v_pk_mul_f32 v[144:145], v[144:145], v[202:203] op_sel_hi:[1,0]
    v_pk_mul_f32 v[146:147], v[146:147], v[202:203] op_sel_hi:[1,0]
    v_pk_mul_f32 v[148:149], v[148:149], v[202:203] op_sel_hi:[1,0]
    v_pk_mul_f32 v[150:151], v[150:151], v[202:203] op_sel_hi:[1,0]
    v_cvt_pk_bf16_f32 v212, v144, v145
    v_cvt_pk_bf16_f32 v213, v146, v147
    v_cvt_pk_bf16_f32 v214, v148, v149
    v_cvt_pk_bf16_f32 v215, v150, v151
    buffer_store_dwordx4 v[212:215], v2, s[24:27], s45 offen sc1
    s_add_u32 s45, s45, 131072
    s_add_u32 s47, s47, 1
    s_cmp_lt_u32 s47, 2
    s_cbranch_scc1 K2_aloop
    s_cmp_eq_u32 s33, 3
    s_cbranch_scc0 K2_ncp
    s_getpc_b64 s[64:65]
CP_k2:
    s_add_u32 s64, s64, k3_kernel-CP_k2
    s_addc_u32 s65, s65, 0
    v_lshlrev_b32 v8, 7, v1
    v_min_u32 v10, CODE_END-k3_kernel-4, v8
    global_load_dword v9, v10, s[64:65]
K2_ncp:
K2_end:
    s_endpgm
.globl k3_kernel
.p2align 8
.type k3_kernel,@function
k3_kernel:
    s_cmp_ge_u32 s2, 256
    s_cbranch_scc1 K3_end
    s_load_dwordx2 s[4:5], s[0:1], 16
    s_load_dwordx4 s[8:11], s[0:1], 48
    s_load_dwordx2 s[14:15], s[0:1], 72
    s_load_dwordx2 s[12:13], s[0:1], 88
    v_and_b32 v1, 63, v0
    v_lshrrev_b32 v2, 6, v0
    s_and_b32 s34, s2, 7
    v_readfirstlane_b32 s33, v2
    s_lshr_b32 s35, s2, 3
    v_lshlrev_b32 v2, 4, v1
    s_lshl_b32 s36, s34, 2
    s_lshr_b32 s37, s35, 3
    s_add_u32 s36, s36, s37
    s_and_b32 s37, s35, 7
    v_lshrrev_b32 v3, 3, v1
    v_bfe_u32 v4, v1, 4, 1
    v_lshlrev_b32 v4, 2, v4
    v_and_b32 v5, 7, v1
    v_xor_b32 v4, v4, v5
    v_lshlrev_b32 v4, 4, v4
    s_lshl_b32 s40, s33, 14
    s_cmp_eq_u32 s33, 0
    s_cbranch_scc0 K3_mlp2
    v_lshl_add_u32 v8, v3, 10, v4
    s_lshl_b32 s41, s37, 7
    s_lshl_b32 s42, s36, 16
    s_add_u32 s42, s42, 15728640
    s_sub_u32 s46, 524288, s41
    s_mov_b32 s44, 32
    s_waitcnt lgkmcnt(0)
    s_add_u32 s16, s4, s41
    s_addc_u32 s17, s5, 0
    s_and_b32 s17, s17, 0xffff
    s_mov_b32 s18, s46
    s_mov_b32 s19, 0x00020000
    s_add_u32 s20, s12, s42
    s_addc_u32 s21, s13, 0
    s_and_b32 s21, s21, 0xffff
    s_mov_b32 s22, 0x10000
    s_mov_b32 s23, 0x00020000
    s_mov_b32 s48, 0
    s_mov_b32 s49, 0
    s_add_u32 m0, s40, 0
    s_add_u32 s50, s48, 8192
    buffer_load_dwordx4 v8, s[16:19], s48 offen lds
    s_add_u32 m0, s40, 1024
    buffer_load_dwordx4 v[80:83], v2, s[20:23], s49 offen
    buffer_load_dwordx4 v8, s[16:19], s50 offen lds
    buffer_load_dwordx4 v[84:87], v2, s[20:23], s49 offen offset:1024
    s_add_u32 s48, s48, 16384
    s_add_u32 s49, s49, 2048
    s_add_u32 m0, s40, 2048
    s_add_u32 s50, s48, 8192
    buffer_load_dwordx4 v8, s[16:19], s48 offen lds
    s_add_u32 m0, s40, 3072
    buffer_load_dwordx4 v[88:91], v2, s[20:23], s49 offen
    buffer_load_dwordx4 v8, s[16:19], s50 offen lds
    buffer_load_dwordx4 v[92:95], v2, s[20:23], s49 offen offset:1024
    s_add_u32 s48, s48, 16384
    s_add_u32 s49, s49, 2048
    s_add_u32 m0, s40, 4096
    s_add_u32 s50, s48, 8192
    buffer_load_dwordx4 v8, s[16:19], s48 offen lds
    s_add_u32 m0, s40, 5120
    buffer_load_dwordx4 v[96:99], v2, s[20:23], s49 offen
    buffer_load_dwordx4 v8, s[16:19], s50 offen lds
    buffer_load_dwordx4 v[100:103], v2, s[20:23], s49 offen offset:1024
    s_add_u32 s48, s48, 16384
    s_add_u32 s49, s49, 2048
    s_add_u32 m0, s40, 6144
    s_add_u32 s50, s48, 8192
    buffer_load_dwordx4 v8, s[16:19], s48 offen lds
    s_add_u32 m0, s40, 7168
    buffer_load_dwordx4 v[104:107], v2, s[20:23], s49 offen
    buffer_load_dwordx4 v8, s[16:19], s50 offen lds
    buffer_load_dwordx4 v[108:111], v2, s[20:23], s49 offen offset:1024
    s_add_u32 s48, s48, 16384
    s_add_u32 s49, s49, 2048
    s_add_u32 m0, s40, 8192
    s_add_u32 s50, s48, 8192
    buffer_load_dwordx4 v8, s[16:19], s48 offen lds
    s_add_u32 m0, s40, 9216
    buffer_load_dwordx4 v[112:115], v2, s[20:23], s49 offen
    buffer_load_dwordx4 v8, s[16:19], s50 offen lds
    buffer_load_dwordx4 v[116:119], v2, s[20:23], s49 offen offset:1024
    s_add_u32 s48, s48, 16384
    s_add_u32 s49, s49, 2048
    s_add_u32 m0, s40, 10240
    s_add_u32 s50, s48, 8192
    buffer_load_dwordx4 v8, s[16:19], s48 offen lds
    s_add_u32 m0, s40, 11264
    buffer_load_dwordx4 v[120:123], v2, s[20:23], s49 offen
    buffer_load_dwordx4 v8, s[16:19], s50 offen lds
    buffer_load_dwordx4 v[124:127], v2, s[20:23], s49 offen offset:1024
    s_add_u32 s48, s48, 16384
    s_add_u32 s49, s49, 2048
    s_add_u32 m0, s40, 12288
    s_add_u32 s50, s48, 8192
    buffer_load_dwordx4 v8, s[16:19], s48 offen lds
    s_add_u32 m0, s40, 13312
    buffer_load_dwordx4 v[128:131], v2, s[20:23], s49 offen
    buffer_load_dwordx4 v8, s[16:19], s50 offen lds
    buffer_load_dwordx4 v[132:135], v2, s[20:23], s49 offen offset:1024
    s_add_u32 s48, s48, 16384
    s_add_u32 s49, s49, 2048
    v_bfe_u32 v6, v1, 2, 2
    v_lshlrev_b32 v6, 7, v6
    v_bfe_u32 v7, v1, 3, 1
    v_lshl_add_u32 v6, v7, 6, v6
    v_bfe_u32 v7, v1, 4, 1
    v_lshl_add_u32 v6, v7, 5, v6
    v_and_b32 v7, 3, v1
    v_lshl_add_u32 v6, v7, 3, v6
    v_add_u32 v6, s40, v6
    v_lshrrev_b32 v7, 5, v1
    v_lshl_add_u32 v10, v7, 9, v6
    v_xor_b32 v11, 64, v10
    v_mov_b64 v[16:17], 0
    v_mov_b64 v[18:19], 0
    v_mov_b64 v[20:21], 0
    v_mov_b64 v[22:23], 0
    v_mov_b64 v[24:25], 0
    v_mov_b64 v[26:27], 0
    v_mov_b64 v[28:29], 0
    v_mov_b64 v[30:31], 0
    v_mov_b64 v[32:33], 0
    v_mov_b64 v[34:35], 0
    v_mov_b64 v[36:37], 0
    v_mov_b64 v[38:39], 0
    v_mov_b64 v[40:41], 0
    v_mov_b64 v[42:43], 0
    v_mov_b64 v[44:45], 0
    v_mov_b64 v[46:47], 0
    v_mov_b64 v[48:49], 0
    v_mov_b64 v[50:51], 0
    v_mov_b64 v[52:53], 0
    v_mov_b64 v[54:55], 0
    v_mov_b64 v[56:57], 0
    v_mov_b64 v[58:59], 0
    v_mov_b64 v[60:61], 0
    v_mov_b64 v[62:63], 0
    v_mov_b64 v[64:65], 0
    v_mov_b64 v[66:67], 0
    v_mov_b64 v[68:69], 0
    v_mov_b64 v[70:71], 0
    v_mov_b64 v[72:73], 0
    v_mov_b64 v[74:75], 0
    v_mov_b64 v[76:77], 0
    v_mov_b64 v[78:79], 0
    s_sub_u32 s51, s44, 2
    s_waitcnt vmcnt(24)
    ds_read_b64_tr_b16 v[144:145], v10 offset:0
    ds_read_b64_tr_b16 v[146:147], v10 offset:1024
    ds_read_b64_tr_b16 v[148:149], v11 offset:0
    ds_read_b64_tr_b16 v[150:151], v11 offset:1024
K3_loop0:
    s_cmp_lt_i32 s51, 5
    s_cbranch_scc1 K3_loop0_t0
    s_waitcnt vmcnt(20)
K3_loop0_r0:
    ds_read_b64_tr_b16 v[152:153], v10 offset:2048
    ds_read_b64_tr_b16 v[154:155], v10 offset:3072
    ds_read_b64_tr_b16 v[156:157], v11 offset:2048
    ds_read_b64_tr_b16 v[158:159], v11 offset:3072
    s_waitcnt lgkmcnt(4)
    v_mfma_f32_32x32x16_bf16 v[16:31], v[144:147], v[80:83], v[16:31]
    v_mfma_f32_32x32x16_bf16 v[32:47], v[144:147], v[84:87], v[32:47]
    s_cmp_lt_i32 s51, 6
    s_cbranch_scc1 K3_loop0_s0
    s_add_u32 m0, s40, 14336
    s_add_u32 s50, s48, 8192
    buffer_load_dwordx4 v8, s[16:19], s48 offen lds
    s_add_u32 m0, s40, 15360
    buffer_load_dwordx4 v[136:139], v2, s[20:23], s49 offen
    buffer_load_dwordx4 v8, s[16:19], s50 offen lds
    buffer_load_dwordx4 v[140:143], v2, s[20:23], s49 offen offset:1024
    s_add_u32 s48, s48, 16384
    s_add_u32 s49, s49, 2048
K3_loop0_s0:
    v_mfma_f32_32x32x16_bf16 v[48:63], v[148:151], v[80:83], v[48:63]
    v_mfma_f32_32x32x16_bf16 v[64:79], v[148:151], v[84:87], v[64:79]
    s_sub_u32 s51, s51, 1
    s_cmp_lt_i32 s51, -1
    s_cbranch_scc1 K3_red
    s_cmp_lt_i32 s51, 5
    s_cbranch_scc1 K3_loop0_t1
    s_waitcnt vmcnt(20)
K3_loop0_r1:
    ds_read_b64_tr_b16 v[144:145], v10 offset:4096
    ds_read_b64_tr_b16 v[146:147], v10 offset:5120
    ds_read_b64_tr_b16 v[148:149], v11 offset:4096
    ds_read_b64_tr_b16 v[150:151], v11 offset:5120
    s_waitcnt lgkmcnt(4)
    v_mfma_f32_32x32x16_bf16 v[16:31], v[152:155], v[88:91], v[16:31]
    v_mfma_f32_32x32x16_bf16 v[32:47], v[152:155], v[92:95], v[32:47]
    s_cmp_lt_i32 s51, 6
    s_cbranch_scc1 K3_loop0_s1
    s_add_u32 m0, s40, 0
    s_add_u32 s50, s48, 8192
    buffer_load_dwordx4 v8, s[16:19], s48 offen lds
    s_add_u32 m0, s40, 1024
    buffer_load_dwordx4 v[80:83], v2, s[20:23], s49 offen
    buffer_load_dwordx4 v8, s[16:19], s50 offen lds
    buffer_load_dwordx4 v[84:87], v2, s[20:23], s49 offen offset:1024
    s_add_u32 s48, s48, 16384
    s_add_u32 s49, s49, 2048
K3_loop0_s1:
    v_mfma_f32_32x32x16_bf16 v[48:63], v[156:159], v[88:91], v[48:63]
    v_mfma_f32_32x32x16_bf16 v[64:79], v[156:159], v[92:95], v[64:79]
    s_sub_u32 s51, s51, 1
    s_cmp_lt_i32 s51, -1
    s_cbranch_scc1 K3_red
    s_cmp_lt_i32 s51, 5
    s_cbranch_scc1 K3_loop0_t2
    s_waitcnt vmcnt(20)
K3_loop0_r2:
    ds_read_b64_tr_b16 v[152:153], v10 offset:6144
    ds_read_b64_tr_b16 v[154:155], v10 offset:7168
    ds_read_b64_tr_b16 v[156:157], v11 offset:6144
    ds_read_b64_tr_b16 v[158:159], v11 offset:7168
    s_waitcnt lgkmcnt(4)
    v_mfma_f32_32x32x16_bf16 v[16:31], v[144:147], v[96:99], v[16:31]
    v_mfma_f32_32x32x16_bf16 v[32:47], v[144:147], v[100:103], v[32:47]
    s_cmp_lt_i32 s51, 6
    s_cbranch_scc1 K3_loop0_s2
    s_add_u32 m0, s40, 2048
    s_add_u32 s50, s48, 8192
    buffer_load_dwordx4 v8, s[16:19], s48 offen lds
    s_add_u32 m0, s40, 3072
    buffer_load_dwordx4 v[88:91], v2, s[20:23], s49 offen
    buffer_load_dwordx4 v8, s[16:19], s50 offen lds
    buffer_load_dwordx4 v[92:95], v2, s[20:23], s49 offen offset:1024
    s_add_u32 s48, s48, 16384
    s_add_u32 s49, s49, 2048
K3_loop0_s2:
    v_mfma_f32_32x32x16_bf16 v[48:63], v[148:151], v[96:99], v[48:63]
    v_mfma_f32_32x32x16_bf16 v[64:79], v[148:151], v[100:103], v[64:79]
    s_sub_u32 s51, s51, 1
    s_cmp_lt_i32 s51, -1
    s_cbranch_scc1 K3_red
    s_cmp_lt_i32 s51, 5
    s_cbranch_scc1 K3_loop0_t3
    s_waitcnt vmcnt(20)
K3_loop0_r3:
    ds_read_b64_tr_b16 v[144:145], v10 offset:8192
    ds_read_b64_tr_b16 v[146:147], v10 offset:9216
    ds_read_b64_tr_b16 v[148:149], v11 offset:8192
    ds_read_b64_tr_b16 v[150:151], v11 offset:9216
    s_waitcnt lgkmcnt(4)
    v_mfma_f32_32x32x16_bf16 v[16:31], v[152:155], v[104:107], v[16:31]
    v_mfma_f32_32x32x16_bf16 v[32:47], v[152:155], v[108:111], v[32:47]
    s_cmp_lt_i32 s51, 6
    s_cbranch_scc1 K3_loop0_s3
    s_add_u32 m0, s40, 4096
    s_add_u32 s50, s48, 8192
    buffer_load_dwordx4 v8, s[16:19], s48 offen lds
    s_add_u32 m0, s40, 5120
    buffer_load_dwordx4 v[96:99], v2, s[20:23], s49 offen
    buffer_load_dwordx4 v8, s[16:19], s50 offen lds
    buffer_load_dwordx4 v[100:103], v2, s[20:23], s49 offen offset:1024
    s_add_u32 s48, s48, 16384
    s_add_u32 s49, s49, 2048
K3_loop0_s3:
    v_mfma_f32_32x32x16_bf16 v[48:63], v[156:159], v[104:107], v[48:63]
    v_mfma_f32_32x32x16_bf16 v[64:79], v[156:159], v[108:111], v[64:79]
    s_sub_u32 s51, s51, 1
    s_cmp_lt_i32 s51, -1
    s_cbranch_scc1 K3_red
    s_cmp_lt_i32 s51, 5
    s_cbranch_scc1 K3_loop0_t4
    s_waitcnt vmcnt(20)
K3_loop0_r4:
    ds_read_b64_tr_b16 v[152:153], v10 offset:10240
    ds_read_b64_tr_b16 v[154:155], v10 offset:11264
    ds_read_b64_tr_b16 v[156:157], v11 offset:10240
    ds_read_b64_tr_b16 v[158:159], v11 offset:11264
    s_waitcnt lgkmcnt(4)
    v_mfma_f32_32x32x16_bf16 v[16:31], v[144:147], v[112:115], v[16:31]
    v_mfma_f32_32x32x16_bf16 v[32:47], v[144:147], v[116:119], v[32:47]
    s_cmp_lt_i32 s51, 6
    s_cbranch_scc1 K3_loop0_s4
    s_add_u32 m0, s40, 6144
    s_add_u32 s50, s48, 8192
    buffer_load_dwordx4 v8, s[16:19], s48 offen lds
    s_add_u32 m0, s40, 7168
    buffer_load_dwordx4 v[104:107], v2, s[20:23], s49 offen
    buffer_load_dwordx4 v8, s[16:19], s50 offen lds
    buffer_load_dwordx4 v[108:111], v2, s[20:23], s49 offen offset:1024
    s_add_u32 s48, s48, 16384
    s_add_u32 s49, s49, 2048
K3_loop0_s4:
    v_mfma_f32_32x32x16_bf16 v[48:63], v[148:151], v[112:115], v[48:63]
    v_mfma_f32_32x32x16_bf16 v[64:79], v[148:151], v[116:119], v[64:79]
    s_sub_u32 s51, s51, 1
    s_cmp_lt_i32 s51, -1
    s_cbranch_scc1 K3_red
    s_cmp_lt_i32 s51, 5
    s_cbranch_scc1 K3_loop0_t5
    s_waitcnt vmcnt(20)
K3_loop0_r5:
    ds_read_b64_tr_b16 v[144:145], v10 offset:12288
    ds_read_b64_tr_b16 v[146:147], v10 offset:13312
    ds_read_b64_tr_b16 v[148:149], v11 offset:12288
    ds_read_b64_tr_b16 v[150:151], v11 offset:13312
    s_waitcnt lgkmcnt(4)
    v_mfma_f32_32x32x16_bf16 v[16:31], v[152:155], v[120:123], v[16:31]
    v_mfma_f32_32x32x16_bf16 v[32:47], v[152:155], v[124:127], v[32:47]
    s_cmp_lt_i32 s51, 6
    s_cbranch_scc1 K3_loop0_s5
    s_add_u32 m0, s40, 8192
    s_add_u32 s50, s48, 8192
    buffer_load_dwordx4 v8, s[16:19], s48 offen lds
    s_add_u32 m0, s40, 9216
    buffer_load_dwordx4 v[112:115], v2, s[20:23], s49 offen
    buffer_load_dwordx4 v8, s[16:19], s50 offen lds
    buffer_load_dwordx4 v[116:119], v2, s[20:23], s49 offen offset:1024
    s_add_u32 s48, s48, 16384
    s_add_u32 s49, s49, 2048
K3_loop0_s5:
    v_mfma_f32_32x32x16_bf16 v[48:63], v[156:159], v[120:123], v[48:63]
    v_mfma_f32_32x32x16_bf16 v[64:79], v[156:159], v[124:127], v[64:79]
    s_sub_u32 s51, s51, 1
    s_cmp_lt_i32 s51, -1
    s_cbranch_scc1 K3_red
    s_cmp_lt_i32 s51, 5
    s_cbranch_scc1 K3_loop0_t6
    s_waitcnt vmcnt(20)
K3_loop0_r6:
    ds_read_b64_tr_b16 v[152:153], v10 offset:14336
    ds_read_b64_tr_b16 v[154:155], v10 offset:15360
    ds_read_b64_tr_b16 v[156:157], v11 offset:14336
    ds_read_b64_tr_b16 v[158:159], v11 offset:15360
    s_waitcnt lgkmcnt(4)
    v_mfma_f32_32x32x16_bf16 v[16:31], v[144:147], v[128:131], v[16:31]
    v_mfma_f32_32x32x16_bf16 v[32:47], v[144:147], v[132:135], v[32:47]
    s_cmp_lt_i32 s51, 6
    s_cbranch_scc1 K3_loop0_s6
    s_add_u32 m0, s40, 10240
    s_add_u32 s50, s48, 8192
    buffer_load_dwordx4 v8, s[16:19], s48 offen lds
    s_add_u32 m0, s40, 11264
    buffer_load_dwordx4 v[120:123], v2, s[20:23], s49 offen
    buffer_load_dwordx4 v8, s[16:19], s50 offen lds
    buffer_load_dwordx4 v[124:127], v2, s[20:23], s49 offen offset:1024
    s_add_u32 s48, s48, 16384
    s_add_u32 s49, s49, 2048
K3_loop0_s6:
    v_mfma_f32_32x32x16_bf16 v[48:63], v[148:151], v[128:131], v[48:63]
    v_mfma_f32_32x32x16_bf16 v[64:79], v[148:151], v[132:135], v[64:79]
    s_sub_u32 s51, s51, 1
    s_cmp_lt_i32 s51, -1
    s_cbranch_scc1 K3_red
    s_cmp_lt_i32 s51, 5
    s_cbranch_scc1 K3_loop0_t7
    s_waitcnt vmcnt(20)
K3_loop0_r7:
    ds_read_b64_tr_b16 v[144:145], v10 offset:0
    ds_read_b64_tr_b16 v[146:147], v10 offset:1024
    ds_read_b64_tr_b16 v[148:149], v11 offset:0
    ds_read_b64_tr_b16 v[150:151], v11 offset:1024
    s_waitcnt lgkmcnt(4)
    v_mfma_f32_32x32x16_bf16 v[16:31], v[152:155], v[136:139], v[16:31]
    v_mfma_f32_32x32x16_bf16 v[32:47], v[152:155], v[140:143], v[32:47]
    s_cmp_lt_i32 s51, 6
    s_cbranch_scc1 K3_loop0_s7
    s_add_u32 m0, s40, 12288
    s_add_u32 s50, s48, 8192
    buffer_load_dwordx4 v8, s[16:19], s48 offen lds
    s_add_u32 m0, s40, 13312
    buffer_load_dwordx4 v[128:131], v2, s[20:23], s49 offen
    buffer_load_dwordx4 v8, s[16:19], s50 offen lds
    buffer_load_dwordx4 v[132:135], v2, s[20:23], s49 offen offset:1024
    s_add_u32 s48, s48, 16384
    s_add_u32 s49, s49, 2048
K3_loop0_s7:
    v_mfma_f32_32x32x16_bf16 v[48:63], v[156:159], v[136:139], v[48:63]
    v_mfma_f32_32x32x16_bf16 v[64:79], v[156:159], v[140:143], v[64:79]
    s_sub_u32 s51, s51, 1
    s_cmp_lt_i32 s51, -1
    s_cbranch_scc0 K3_loop0
    s_branch K3_red
K3_loop0_t0:
    s_cmp_lt_i32 s51, 2
    s_cbranch_scc1 K3_loop0_u0
    s_waitcnt vmcnt(8)
    s_branch K3_loop0_r0
K3_loop0_u0:
    s_waitcnt vmcnt(0)
    s_branch K3_loop0_r0
K3_loop0_t1:
    s_cmp_lt_i32 s51, 2
    s_cbranch_scc1 K3_loop0_u1
    s_waitcnt vmcnt(8)
    s_branch K3_loop0_r1
K3_loop0_u1:
    s_waitcnt vmcnt(0)
    s_branch K3_loop0_r1
K3_loop0_t2:
    s_cmp_lt_i32 s51, 2
    s_cbranch_scc1 K3_loop0_u2
    s_waitcnt vmcnt(8)
    s_branch K3_loop0_r2
K3_loop0_u2:
    s_waitcnt vmcnt(0)
    s_branch K3_loop0_r2
K3_loop0_t3:
    s_cmp_lt_i32 s51, 2
    s_cbranch_scc1 K3_loop0_u3
    s_waitcnt vmcnt(8)
    s_branch K3_loop0_r3
K3_loop0_u3:
    s_waitcnt vmcnt(0)
    s_branch K3_loop0_r3
K3_loop0_t4:
    s_cmp_lt_i32 s51, 2
    s_cbranch_scc1 K3_loop0_u4
    s_waitcnt vmcnt(8)
    s_branch K3_loop0_r4
K3_loop0_u4:
    s_waitcnt vmcnt(0)
    s_branch K3_loop0_r4
K3_loop0_t5:
    s_cmp_lt_i32 s51, 2
    s_cbranch_scc1 K3_loop0_u5
    s_waitcnt vmcnt(8)
    s_branch K3_loop0_r5
K3_loop0_u5:
    s_waitcnt vmcnt(0)
    s_branch K3_loop0_r5
K3_loop0_t6:
    s_cmp_lt_i32 s51, 2
    s_cbranch_scc1 K3_loop0_u6
    s_waitcnt vmcnt(8)
    s_branch K3_loop0_r6
K3_loop0_u6:
    s_waitcnt vmcnt(0)
    s_branch K3_loop0_r6
K3_loop0_t7:
    s_cmp_lt_i32 s51, 2
    s_cbranch_scc1 K3_loop0_u7
    s_waitcnt vmcnt(8)
    s_branch K3_loop0_r7
K3_loop0_u7:
    s_waitcnt vmcnt(0)
    s_branch K3_loop0_r7
K3_mlp2:
    v_lshl_add_u32 v8, v3, 12, v4
    s_sub_u32 s43, s33, 1
    s_mul_i32 s43, s43, 29
    s_cmp_eq_u32 s33, 3
    s_cselect_b32 s44, 28, 29
    s_lshl_b32 s41, s43, 16
    s_lshl_b32 s45, s36, 7
    s_add_u32 s41, s41, s45
    s_mul_i32 s42, s37, 176128
    s_lshl_b32 s46, s43, 11
    s_add_u32 s42, s42, s46
    s_add_u32 s42, s42, 17825792
    s_lshl_b32 s46, s44, 16
    s_sub_u32 s46, s46, s45
    s_lshl_b32 s47, s44, 11
    s_waitcnt lgkmcnt(0)
    s_add_u32 s16, s8, s41
    s_addc_u32 s17, s9, 0
    s_and_b32 s17, s17, 0xffff
    s_mov_b32 s18, s46
    s_mov_b32 s19, 0x00020000
    s_add_u32 s20, s12, s42
    s_addc_u32 s21, s13, 0
    s_and_b32 s21, s21, 0xffff
    s_mov_b32 s22, s47
    s_mov_b32 s23, 0x00020000
    s_mov_b32 s48, 0
    s_mov_b32 s49, 0
    s_add_u32 m0, s40, 0
    s_add_u32 s50, s48, 32768
    buffer_load_dwordx4 v8, s[16:19], s48 offen lds
    s_add_u32 m0, s40, 1024
    buffer_load_dwordx4 v[80:83], v2, s[20:23], s49 offen
    buffer_load_dwordx4 v8, s[16:19], s50 offen lds
    buffer_load_dwordx4 v[84:87], v2, s[20:23], s49 offen offset:1024
    s_add_u32 s48, s48, 65536
    s_add_u32 s49, s49, 2048
    s_add_u32 m0, s40, 2048
    s_add_u32 s50, s48, 32768
    buffer_load_dwordx4 v8, s[16:19], s48 offen lds
    s_add_u32 m0, s40, 3072
    buffer_load_dwordx4 v[88:91], v2, s[20:23], s49 offen
    buffer_load_dwordx4 v8, s[16:19], s50 offen lds
    buffer_load_dwordx4 v[92:95], v2, s[20:23], s49 offen offset:1024
    s_add_u32 s48, s48, 65536
    s_add_u32 s49, s49, 2048
    s_add_u32 m0, s40, 4096
    s_add_u32 s50, s48, 32768
    buffer_load_dwordx4 v8, s[16:19], s48 offen lds
    s_add_u32 m0, s40, 5120
    buffer_load_dwordx4 v[96:99], v2, s[20:23], s49 offen
    buffer_load_dwordx4 v8, s[16:19], s50 offen lds
    buffer_load_dwordx4 v[100:103], v2, s[20:23], s49 offen offset:1024
    s_add_u32 s48, s48, 65536
    s_add_u32 s49, s49, 2048
    s_add_u32 m0, s40, 6144
    s_add_u32 s50, s48, 32768
    buffer_load_dwordx4 v8, s[16:19], s48 offen lds
    s_add_u32 m0, s40, 7168
    buffer_load_dwordx4 v[104:107], v2, s[20:23], s49 offen
    buffer_load_dwordx4 v8, s[16:19], s50 offen lds
    buffer_load_dwordx4 v[108:111], v2, s[20:23], s49 offen offset:1024
    s_add_u32 s48, s48, 65536
    s_add_u32 s49, s49, 2048
    s_add_u32 m0, s40, 8192
    s_add_u32 s50, s48, 32768
    buffer_load_dwordx4 v8, s[16:19], s48 offen lds
    s_add_u32 m0, s40, 9216
    buffer_load_dwordx4 v[112:115], v2, s[20:23], s49 offen
    buffer_load_dwordx4 v8, s[16:19], s50 offen lds
    buffer_load_dwordx4 v[116:119], v2, s[20:23], s49 offen offset:1024
    s_add_u32 s48, s48, 65536
    s_add_u32 s49, s49, 2048
    s_add_u32 m0, s40, 10240
    s_add_u32 s50, s48, 32768
    buffer_load_dwordx4 v8, s[16:19], s48 offen lds
    s_add_u32 m0, s40, 11264
    buffer_load_dwordx4 v[120:123], v2, s[20:23], s49 offen
    buffer_load_dwordx4 v8, s[16:19], s50 offen lds
    buffer_load_dwordx4 v[124:127], v2, s[20:23], s49 offen offset:1024
    s_add_u32 s48, s48, 65536
    s_add_u32 s49, s49, 2048
    s_add_u32 m0, s40, 12288
    s_add_u32 s50, s48, 32768
    buffer_load_dwordx4 v8, s[16:19], s48 offen lds
    s_add_u32 m0, s40, 13312
    buffer_load_dwordx4 v[128:131], v2, s[20:23], s49 offen
    buffer_load_dwordx4 v8, s[16:19], s50 offen lds
    buffer_load_dwordx4 v[132:135], v2, s[20:23], s49 offen offset:1024
    s_add_u32 s48, s48, 65536
    s_add_u32 s49, s49, 2048
    v_bfe_u32 v6, v1, 2, 2
    v_lshlrev_b32 v6, 7, v6
    v_bfe_u32 v7, v1, 3, 1
    v_lshl_add_u32 v6, v7, 6, v6
    v_bfe_u32 v7, v1, 4, 1
    v_lshl_add_u32 v6, v7, 5, v6
    v_and_b32 v7, 3, v1
    v_lshl_add_u32 v6, v7, 3, v6
    v_add_u32 v6, s40, v6
    v_lshrrev_b32 v7, 5, v1
    v_lshl_add_u32 v10, v7, 10, v6
    v_xor_b32 v11, 64, v10
    v_mov_b64 v[16:17], 0
    v_mov_b64 v[18:19], 0
    v_mov_b64 v[20:21], 0
    v_mov_b64 v[22:23], 0
    v_mov_b64 v[24:25], 0
    v_mov_b64 v[26:27], 0
    v_mov_b64 v[28:29], 0
    v_mov_b64 v[30:31], 0
    v_mov_b64 v[32:33], 0
    v_mov_b64 v[34:35], 0
    v_mov_b64 v[36:37], 0
    v_mov_b64 v[38:39], 0
    v_mov_b64 v[40:41], 0
    v_mov_b64 v[42:43], 0
    v_mov_b64 v[44:45], 0
    v_mov_b64 v[46:47], 0
    v_mov_b64 v[48:49], 0
    v_mov_b64 v[50:51], 0
    v_mov_b64 v[52:53], 0
    v_mov_b64 v[54:55], 0
    v_mov_b64 v[56:57], 0
    v_mov_b64 v[58:59], 0
    v_mov_b64 v[60:61], 0
    v_mov_b64 v[62:63], 0
    v_mov_b64 v[64:65], 0
    v_mov_b64 v[66:67], 0
    v_mov_b64 v[68:69], 0
    v_mov_b64 v[70:71], 0
    v_mov_b64 v[72:73], 0
    v_mov_b64 v[74:75], 0
    v_mov_b64 v[76:77], 0
    v_mov_b64 v[78:79], 0
    s_sub_u32 s51, s44, 2
    s_waitcnt vmcnt(24)
    ds_read_b64_tr_b16 v[144:145], v10 offset:0
    ds_read_b64_tr_b16 v[146:147], v10 offset:512
    ds_read_b64_tr_b16 v[148:149], v11 offset:0
    ds_read_b64_tr_b16 v[150:151], v11 offset:512
K3_loop1:
    s_cmp_lt_i32 s51, 5
    s_cbranch_scc1 K3_loop1_t0
    s_waitcnt vmcnt(20)
K3_loop1_r0:
    ds_read_b64_tr_b16 v[152:153], v10 offset:2048
    ds_read_b64_tr_b16 v[154:155], v10 offset:2560
    ds_read_b64_tr_b16 v[156:157], v11 offset:2048
    ds_read_b64_tr_b16 v[158:159], v11 offset:2560
    s_waitcnt lgkmcnt(4)
    v_mfma_f32_32x32x16_bf16 v[16:31], v[80:83], v[144:147], v[16:31]
    v_mfma_f32_32x32x16_bf16 v[32:47], v[80:83], v[148:151], v[32:47]
    s_cmp_lt_i32 s51, 6
    s_cbranch_scc1 K3_loop1_s0
    s_add_u32 m0, s40, 14336
    s_add_u32 s50, s48, 32768
    buffer_load_dwordx4 v8, s[16:19], s48 offen lds
    s_add_u32 m0, s40, 15360
    buffer_load_dwordx4 v[136:139], v2, s[20:23], s49 offen
    buffer_load_dwordx4 v8, s[16:19], s50 offen lds
    buffer_load_dwordx4 v[140:143], v2, s[20:23], s49 offen offset:1024
    s_add_u32 s48, s48, 65536
    s_add_u32 s49, s49, 2048
K3_loop1_s0:
    v_mfma_f32_32x32x16_bf16 v[48:63], v[84:87], v[144:147], v[48:63]
    v_mfma_f32_32x32x16_bf16 v[64:79], v[84:87], v[148:151], v[64:79]
    s_sub_u32 s51, s51, 1
    s_cmp_lt_i32 s51, -1
    s_cbranch_scc1 K3_red
    s_cmp_lt_i32 s51, 5
    s_cbranch_scc1 K3_loop1_t1
    s_waitcnt vmcnt(20)
K3_loop1_r1:
    ds_read_b64_tr_b16 v[144:145], v10 offset:4096
    ds_read_b64_tr_b16 v[146:147], v10 offset:4608
    ds_read_b64_tr_b16 v[148:149], v11 offset:4096
    ds_read_b64_tr_b16 v[150:151], v11 offset:4608
    s_waitcnt lgkmcnt(4)
    v_mfma_f32_32x32x16_bf16 v[16:31], v[88:91], v[152:155], v[16:31]
    v_mfma_f32_32x32x16_bf16 v[32:47], v[88:91], v[156:159], v[32:47]
    s_cmp_lt_i32 s51, 6
    s_cbranch_scc1 K3_loop1_s1
    s_add_u32 m0, s40, 0
    s_add_u32 s50, s48, 32768
    buffer_load_dwordx4 v8, s[16:19], s48 offen lds
    s_add_u32 m0, s40, 1024
    buffer_load_dwordx4 v[80:83], v2, s[20:23], s49 offen
    buffer_load_dwordx4 v8, s[16:19], s50 offen lds
    buffer_load_dwordx4 v[84:87], v2, s[20:23], s49 offen offset:1024
    s_add_u32 s48, s48, 65536
    s_add_u32 s49, s49, 2048
K3_loop1_s1:
    v_mfma_f32_32x32x16_bf16 v[48:63], v[92:95], v[152:155], v[48:63]
    v_mfma_f32_32x32x16_bf16 v[64:79], v[92:95], v[156:159], v[64:79]
    s_sub_u32 s51, s51, 1
    s_cmp_lt_i32 s51, -1
    s_cbranch_scc1 K3_red
    s_cmp_lt_i32 s51, 5
    s_cbranch_scc1 K3_loop1_t2
    s_waitcnt vmcnt(20)
K3_loop1_r2:
    ds_read_b64_tr_b16 v[152:153], v10 offset:6144
    ds_read_b64_tr_b16 v[154:155], v10 offset:6656
    ds_read_b64_tr_b16 v[156:157], v11 offset:6144
    ds_read_b64_tr_b16 v[158:159], v11 offset:6656
    s_waitcnt lgkmcnt(4)
    v_mfma_f32_32x32x16_bf16 v[16:31], v[96:99], v[144:147], v[16:31]
    v_mfma_f32_32x32x16_bf16 v[32:47], v[96:99], v[148:151], v[32:47]
    s_cmp_lt_i32 s51, 6
    s_cbranch_scc1 K3_loop1_s2
    s_add_u32 m0, s40, 2048
    s_add_u32 s50, s48, 32768
    buffer_load_dwordx4 v8, s[16:19], s48 offen lds
    s_add_u32 m0, s40, 3072
    buffer_load_dwordx4 v[88:91], v2, s[20:23], s49 offen
    buffer_load_dwordx4 v8, s[16:19], s50 offen lds
    buffer_load_dwordx4 v[92:95], v2, s[20:23], s49 offen offset:1024
    s_add_u32 s48, s48, 65536
    s_add_u32 s49, s49, 2048
K3_loop1_s2:
    v_mfma_f32_32x32x16_bf16 v[48:63], v[100:103], v[144:147], v[48:63]
    v_mfma_f32_32x32x16_bf16 v[64:79], v[100:103], v[148:151], v[64:79]
    s_sub_u32 s51, s51, 1
    s_cmp_lt_i32 s51, -1
    s_cbranch_scc1 K3_red
    s_cmp_lt_i32 s51, 5
    s_cbranch_scc1 K3_loop1_t3
    s_waitcnt vmcnt(20)
K3_loop1_r3:
    ds_read_b64_tr_b16 v[144:145], v10 offset:8192
    ds_read_b64_tr_b16 v[146:147], v10 offset:8704
    ds_read_b64_tr_b16 v[148:149], v11 offset:8192
    ds_read_b64_tr_b16 v[150:151], v11 offset:8704
    s_waitcnt lgkmcnt(4)
    v_mfma_f32_32x32x16_bf16 v[16:31], v[104:107], v[152:155], v[16:31]
    v_mfma_f32_32x32x16_bf16 v[32:47], v[104:107], v[156:159], v[32:47]
    s_cmp_lt_i32 s51, 6
    s_cbranch_scc1 K3_loop1_s3
    s_add_u32 m0, s40, 4096
    s_add_u32 s50, s48, 32768
    buffer_load_dwordx4 v8, s[16:19], s48 offen lds
    s_add_u32 m0, s40, 5120
    buffer_load_dwordx4 v[96:99], v2, s[20:23], s49 offen
    buffer_load_dwordx4 v8, s[16:19], s50 offen lds
    buffer_load_dwordx4 v[100:103], v2, s[20:23], s49 offen offset:1024
    s_add_u32 s48, s48, 65536
    s_add_u32 s49, s49, 2048
K3_loop1_s3:
    v_mfma_f32_32x32x16_bf16 v[48:63], v[108:111], v[152:155], v[48:63]
    v_mfma_f32_32x32x16_bf16 v[64:79], v[108:111], v[156:159], v[64:79]
    s_sub_u32 s51, s51, 1
    s_cmp_lt_i32 s51, -1
    s_cbranch_scc1 K3_red
    s_cmp_lt_i32 s51, 5
    s_cbranch_scc1 K3_loop1_t4
    s_waitcnt vmcnt(20)
K3_loop1_r4:
    ds_read_b64_tr_b16 v[152:153], v10 offset:10240
    ds_read_b64_tr_b16 v[154:155], v10 offset:10752
    ds_read_b64_tr_b16 v[156:157], v11 offset:10240
    ds_read_b64_tr_b16 v[158:159], v11 offset:10752
    s_waitcnt lgkmcnt(4)
    v_mfma_f32_32x32x16_bf16 v[16:31], v[112:115], v[144:147], v[16:31]
    v_mfma_f32_32x32x16_bf16 v[32:47], v[112:115], v[148:151], v[32:47]
    s_cmp_lt_i32 s51, 6
    s_cbranch_scc1 K3_loop1_s4
    s_add_u32 m0, s40, 6144
    s_add_u32 s50, s48, 32768
    buffer_load_dwordx4 v8, s[16:19], s48 offen lds
    s_add_u32 m0, s40, 7168
    buffer_load_dwordx4 v[104:107], v2, s[20:23], s49 offen
    buffer_load_dwordx4 v8, s[16:19], s50 offen lds
    buffer_load_dwordx4 v[108:111], v2, s[20:23], s49 offen offset:1024
    s_add_u32 s48, s48, 65536
    s_add_u32 s49, s49, 2048
K3_loop1_s4:
    v_mfma_f32_32x32x16_bf16 v[48:63], v[116:119], v[144:147], v[48:63]
    v_mfma_f32_32x32x16_bf16 v[64:79], v[116:119], v[148:151], v[64:79]
    s_sub_u32 s51, s51, 1
    s_cmp_lt_i32 s51, -1
    s_cbranch_scc1 K3_red
    s_cmp_lt_i32 s51, 5
    s_cbranch_scc1 K3_loop1_t5
    s_waitcnt vmcnt(20)
K3_loop1_r5:
    ds_read_b64_tr_b16 v[144:145], v10 offset:12288
    ds_read_b64_tr_b16 v[146:147], v10 offset:12800
    ds_read_b64_tr_b16 v[148:149], v11 offset:12288
    ds_read_b64_tr_b16 v[150:151], v11 offset:12800
    s_waitcnt lgkmcnt(4)
    v_mfma_f32_32x32x16_bf16 v[16:31], v[120:123], v[152:155], v[16:31]
    v_mfma_f32_32x32x16_bf16 v[32:47], v[120:123], v[156:159], v[32:47]
    s_cmp_lt_i32 s51, 6
    s_cbranch_scc1 K3_loop1_s5
    s_add_u32 m0, s40, 8192
    s_add_u32 s50, s48, 32768
    buffer_load_dwordx4 v8, s[16:19], s48 offen lds
    s_add_u32 m0, s40, 9216
    buffer_load_dwordx4 v[112:115], v2, s[20:23], s49 offen
    buffer_load_dwordx4 v8, s[16:19], s50 offen lds
    buffer_load_dwordx4 v[116:119], v2, s[20:23], s49 offen offset:1024
    s_add_u32 s48, s48, 65536
    s_add_u32 s49, s49, 2048
K3_loop1_s5:
    v_mfma_f32_32x32x16_bf16 v[48:63], v[124:127], v[152:155], v[48:63]
    v_mfma_f32_32x32x16_bf16 v[64:79], v[124:127], v[156:159], v[64:79]
    s_sub_u32 s51, s51, 1
    s_cmp_lt_i32 s51, -1
    s_cbranch_scc1 K3_red
    s_cmp_lt_i32 s51, 5
    s_cbranch_scc1 K3_loop1_t6
    s_waitcnt vmcnt(20)
K3_loop1_r6:
    ds_read_b64_tr_b16 v[152:153], v10 offset:14336
    ds_read_b64_tr_b16 v[154:155], v10 offset:14848
    ds_read_b64_tr_b16 v[156:157], v11 offset:14336
    ds_read_b64_tr_b16 v[158:159], v11 offset:14848
    s_waitcnt lgkmcnt(4)
    v_mfma_f32_32x32x16_bf16 v[16:31], v[128:131], v[144:147], v[16:31]
    v_mfma_f32_32x32x16_bf16 v[32:47], v[128:131], v[148:151], v[32:47]
    s_cmp_lt_i32 s51, 6
    s_cbranch_scc1 K3_loop1_s6
    s_add_u32 m0, s40, 10240
    s_add_u32 s50, s48, 32768
    buffer_load_dwordx4 v8, s[16:19], s48 offen lds
    s_add_u32 m0, s40, 11264
    buffer_load_dwordx4 v[120:123], v2, s[20:23], s49 offen
    buffer_load_dwordx4 v8, s[16:19], s50 offen lds
    buffer_load_dwordx4 v[124:127], v2, s[20:23], s49 offen offset:1024
    s_add_u32 s48, s48, 65536
    s_add_u32 s49, s49, 2048
K3_loop1_s6:
    v_mfma_f32_32x32x16_bf16 v[48:63], v[132:135], v[144:147], v[48:63]
    v_mfma_f32_32x32x16_bf16 v[64:79], v[132:135], v[148:151], v[64:79]
    s_sub_u32 s51, s51, 1
    s_cmp_lt_i32 s51, -1
    s_cbranch_scc1 K3_red
    s_cmp_lt_i32 s51, 5
    s_cbranch_scc1 K3_loop1_t7
    s_waitcnt vmcnt(20)
K3_loop1_r7:
    ds_read_b64_tr_b16 v[144:145], v10 offset:0
    ds_read_b64_tr_b16 v[146:147], v10 offset:512
    ds_read_b64_tr_b16 v[148:149], v11 offset:0
    ds_read_b64_tr_b16 v[150:151], v11 offset:512
    s_waitcnt lgkmcnt(4)
    v_mfma_f32_32x32x16_bf16 v[16:31], v[136:139], v[152:155], v[16:31]
    v_mfma_f32_32x32x16_bf16 v[32:47], v[136:139], v[156:159], v[32:47]
    s_cmp_lt_i32 s51, 6
    s_cbranch_scc1 K3_loop1_s7
    s_add_u32 m0, s40, 12288
    s_add_u32 s50, s48, 32768
    buffer_load_dwordx4 v8, s[16:19], s48 offen lds
    s_add_u32 m0, s40, 13312
    buffer_load_dwordx4 v[128:131], v2, s[20:23], s49 offen
    buffer_load_dwordx4 v8, s[16:19], s50 offen lds
    buffer_load_dwordx4 v[132:135], v2, s[20:23], s49 offen offset:1024
    s_add_u32 s48, s48, 65536
    s_add_u32 s49, s49, 2048
K3_loop1_s7:
    v_mfma_f32_32x32x16_bf16 v[48:63], v[140:143], v[152:155], v[48:63]
    v_mfma_f32_32x32x16_bf16 v[64:79], v[140:143], v[156:159], v[64:79]
    s_sub_u32 s51, s51, 1
    s_cmp_lt_i32 s51, -1
    s_cbranch_scc0 K3_loop1
    s_branch K3_red
K3_loop1_t0:
    s_cmp_lt_i32 s51, 2
    s_cbranch_scc1 K3_loop1_u0
    s_waitcnt vmcnt(8)
    s_branch K3_loop1_r0
K3_loop1_u0:
    s_waitcnt vmcnt(0)
    s_branch K3_loop1_r0
K3_loop1_t1:
    s_cmp_lt_i32 s51, 2
    s_cbranch_scc1 K3_loop1_u1
    s_waitcnt vmcnt(8)
    s_branch K3_loop1_r1
K3_loop1_u1:
    s_waitcnt vmcnt(0)
    s_branch K3_loop1_r1
K3_loop1_t2:
    s_cmp_lt_i32 s51, 2
    s_cbranch_scc1 K3_loop1_u2
    s_waitcnt vmcnt(8)
    s_branch K3_loop1_r2
K3_loop1_u2:
    s_waitcnt vmcnt(0)
    s_branch K3_loop1_r2
K3_loop1_t3:
    s_cmp_lt_i32 s51, 2
    s_cbranch_scc1 K3_loop1_u3
    s_waitcnt vmcnt(8)
    s_branch K3_loop1_r3
K3_loop1_u3:
    s_waitcnt vmcnt(0)
    s_branch K3_loop1_r3
K3_loop1_t4:
    s_cmp_lt_i32 s51, 2
    s_cbranch_scc1 K3_loop1_u4
    s_waitcnt vmcnt(8)
    s_branch K3_loop1_r4
K3_loop1_u4:
    s_waitcnt vmcnt(0)
    s_branch K3_loop1_r4
K3_loop1_t5:
    s_cmp_lt_i32 s51, 2
    s_cbranch_scc1 K3_loop1_u5
    s_waitcnt vmcnt(8)
    s_branch K3_loop1_r5
K3_loop1_u5:
    s_waitcnt vmcnt(0)
    s_branch K3_loop1_r5
K3_loop1_t6:
    s_cmp_lt_i32 s51, 2
    s_cbranch_scc1 K3_loop1_u6
    s_waitcnt vmcnt(8)
    s_branch K3_loop1_r6
K3_loop1_u6:
    s_waitcnt vmcnt(0)
    s_branch K3_loop1_r6
K3_loop1_t7:
    s_cmp_lt_i32 s51, 2
    s_cbranch_scc1 K3_loop1_u7
    s_waitcnt vmcnt(8)
    s_branch K3_loop1_r7
K3_loop1_u7:
    s_waitcnt vmcnt(0)
    s_branch K3_loop1_r7
K3_red:
    s_mov_b32 s24, s12
    s_and_b32 s25, s13, 0xffff
    s_mov_b32 s26, 0x1300000
    s_mov_b32 s27, 0x00020000
    s_mov_b32 s28, s10
    s_and_b32 s29, s11, 0xffff
    s_mov_b32 s30, 0x1000
    s_mov_b32 s31, 0x00020000
    s_mov_b32 s44, s14
    s_and_b32 s45, s15, 0xffff
    s_mov_b32 s46, 0x200000
    s_mov_b32 s47, 0x00020000
    s_lshl_b32 s52, s36, 6
    s_lshl_b32 s53, s33, 4
    s_add_u32 s52, s52, s53
    s_lshl_b32 s53, s52, 2
    s_add_u32 s53, s53, 14680064
    s_lshl_b32 s54, s52, 1
    v_lshlrev_b32 v4, 2, v3
    v_lshlrev_b32 v5, 1, v3
    buffer_load_dword v12, v4, s[24:27], s53 offen
    buffer_load_dword v13, v4, s[24:27], s53 offen offset:32
    buffer_load_ushort v14, v5, s[28:31], s54 offen
    buffer_load_ushort v15, v5, s[28:31], s54 offen offset:16
    v_and_b32 v6, 31, v1
    v_mul_u32_u24 v6, 272, v6
    v_lshl_add_u32 v6, v7, 4, v6
    s_mul_i32 s55, s33, 17408
    s_add_u32 s55, s55, 65536
    v_add_u32 v6, s55, v6
    ds_write_b128 v6, v[16:19] offset:0
    ds_write_b128 v6, v[20:23] offset:32
    ds_write_b128 v6, v[24:27] offset:64
    ds_write_b128 v6, v[28:31] offset:96
    ds_write_b128 v6, v[32:35] offset:8704
    ds_write_b128 v6, v[36:39] offset:8736
    ds_write_b128 v6, v[40:43] offset:8768
    ds_write_b128 v6, v[44:47] offset:8800
    ds_write_b128 v6, v[48:51] offset:128
    ds_write_b128 v6, v[52:55] offset:160
    ds_write_b128 v6, v[56:59] offset:192
    ds_write_b128 v6, v[60:63] offset:224
    ds_write_b128 v6, v[64:67] offset:8832
    ds_write_b128 v6, v[68:71] offset:8864
    ds_write_b128 v6, v[72:75] offset:8896
    ds_write_b128 v6, v[76:79] offset:8928
    s_lshl_b32 s55, s33, 4
    v_add_u32 v6, s55, v3
    v_mul_u32_u24 v6, 272, v6
    v_and_b32 v8, 7, v1
    v_lshl_add_u32 v6, v8, 5, v6
    v_add_u32 v6, 65536, v6
    v_lshlrev_b32 v8, 4, v8
    v_lshl_add_u32 v8, v3, 10, v8
    s_lshl_b32 s55, s52, 10
    s_lshl_b32 s56, s37, 7
    s_add_u32 s55, s55, s56
    s_add_u32 s56, s55, 8192
    s_waitcnt lgkmcnt(0)
    s_barrier
    ds_read_b128 v[80:83], v6 offset:0
    ds_read_b128 v[84:87], v6 offset:16
    ds_read_b128 v[88:91], v6 offset:17408
    ds_read_b128 v[92:95], v6 offset:17424
    ds_read_b128 v[96:99], v6 offset:34816
    ds_read_b128 v[100:103], v6 offset:34832
    ds_read_b128 v[104:107], v6 offset:52224
    ds_read_b128 v[108:111], v6 offset:52240
    ds_read_b128 v[112:115], v6 offset:2176
    ds_read_b128 v[116:119], v6 offset:2192
    ds_read_b128 v[120:123], v6 offset:19584
    ds_read_b128 v[124:127], v6 offset:19600
    ds_read_b128 v[128:131], v6 offset:36992
    ds_read_b128 v[132:135], v6 offset:37008
    ds_read_b128 v[136:139], v6 offset:54400
    ds_read_b128 v[140:143], v6 offset:54416
    s_waitcnt vmcnt(0)
    v_lshlrev_b32 v154, 16, v14
    v_sub_f32 v150, 1.0, v12
    v_cvt_pk_bf16_f32 v150, v150, v150
    v_lshlrev_b32 v150, 16, v150
    v_mov_b32 v152, v12
    v_lshlrev_b32 v160, 16, v15
    v_sub_f32 v156, 1.0, v13
    v_cvt_pk_bf16_f32 v156, v156, v156
    v_lshlrev_b32 v156, 16, v156
    v_mov_b32 v158, v13
    s_waitcnt lgkmcnt(8)
    v_pk_add_f32 v[88:89], v[88:89], v[96:97]
    v_pk_add_f32 v[90:91], v[90:91], v[98:99]
    v_pk_add_f32 v[92:93], v[92:93], v[100:101]
    v_pk_add_f32 v[94:95], v[94:95], v[102:103]
    v_pk_add_f32 v[104:105], v[104:105], v[154:155] op_sel_hi:[1,0]
    v_pk_add_f32 v[106:107], v[106:107], v[154:155] op_sel_hi:[1,0]
    v_pk_add_f32 v[108:109], v[108:109], v[154:155] op_sel_hi:[1,0]
    v_pk_add_f32 v[110:111], v[110:111], v[154:155] op_sel_hi:[1,0]
    v_pk_mul_f32 v[80:81], v[80:81], v[152:153] op_sel_hi:[1,0]
    v_pk_mul_f32 v[82:83], v[82:83], v[152:153] op_sel_hi:[1,0]
    v_pk_mul_f32 v[84:85], v[84:85], v[152:153] op_sel_hi:[1,0]
    v_pk_mul_f32 v[86:87], v[86:87], v[152:153] op_sel_hi:[1,0]
    v_pk_add_f32 v[88:89], v[88:89], v[104:105]
    v_pk_add_f32 v[90:91], v[90:91], v[106:107]
    v_pk_add_f32 v[92:93], v[92:93], v[108:109]
    v_pk_add_f32 v[94:95], v[94:95], v[110:111]
    v_pk_fma_f32 v[80:81], v[88:89], v[150:151], v[80:81] op_sel_hi:[1,0,1]
    v_pk_fma_f32 v[82:83], v[90:91], v[150:151], v[82:83] op_sel_hi:[1,0,1]
    v_pk_fma_f32 v[84:85], v[92:93], v[150:151], v[84:85] op_sel_hi:[1,0,1]
    v_pk_fma_f32 v[86:87], v[94:95], v[150:151], v[86:87] op_sel_hi:[1,0,1]
    v_cvt_pk_bf16_f32 v96, v80, v81
    v_cvt_pk_bf16_f32 v97, v82, v83
    v_cvt_pk_bf16_f32 v98, v84, v85
    v_cvt_pk_bf16_f32 v99, v86, v87
    buffer_store_dwordx4 v[96:99], v8, s[44:47], s55 offen sc1
    s_waitcnt lgkmcnt(0)
    v_pk_add_f32 v[120:121], v[120:121], v[128:129]
    v_pk_add_f32 v[122:123], v[122:123], v[130:131]
    v_pk_add_f32 v[124:125], v[124:125], v[132:133]
    v_pk_add_f32 v[126:127], v[126:127], v[134:135]
    v_pk_add_f32 v[136:137], v[136:137], v[160:161] op_sel_hi:[1,0]
    v_pk_add_f32 v[138:139], v[138:139], v[160:161] op_sel_hi:[1,0]
    v_pk_add_f32 v[140:141], v[140:141], v[160:161] op_sel_hi:[1,0]
    v_pk_add_f32 v[142:143], v[142:143], v[160:161] op_sel_hi:[1,0]
    v_pk_mul_f32 v[112:113], v[112:113], v[158:159] op_sel_hi:[1,0]
    v_pk_mul_f32 v[114:115], v[114:115], v[158:159] op_sel_hi:[1,0]
    v_pk_mul_f32 v[116:117], v[116:117], v[158:159] op_sel_hi:[1,0]
    v_pk_mul_f32 v[118:119], v[118:119], v[158:159] op_sel_hi:[1,0]
    v_pk_add_f32 v[120:121], v[120:121], v[136:137]
    v_pk_add_f32 v[122:123], v[122:123], v[138:139]
    v_pk_add_f32 v[124:125], v[124:125], v[140:141]
    v_pk_add_f32 v[126:127], v[126:127], v[142:143]
    v_pk_fma_f32 v[112:113], v[120:121], v[156:157], v[112:113] op_sel_hi:[1,0,1]
    v_pk_fma_f32 v[114:115], v[122:123], v[156:157], v[114:115] op_sel_hi:[1,0,1]
    v_pk_fma_f32 v[116:117], v[124:125], v[156:157], v[116:117] op_sel_hi:[1,0,1]
    v_pk_fma_f32 v[118:119], v[126:127], v[156:157], v[118:119] op_sel_hi:[1,0,1]
    v_cvt_pk_bf16_f32 v128, v112, v113
    v_cvt_pk_bf16_f32 v129, v114, v115
    v_cvt_pk_bf16_f32 v130, v116, v117
    v_cvt_pk_bf16_f32 v131, v118, v119
    buffer_store_dwordx4 v[128:131], v8, s[44:47], s56 offen sc1
K3_end:
    s_endpgm
CODE_END:
.section .rodata,"a"
.p2align 6
.amdhsa_kernel k1_kernel
  .amdhsa_next_free_vgpr 160
  .amdhsa_next_free_sgpr 96
  .amdhsa_accum_offset 160
  .amdhsa_group_segment_fixed_size 0
  .amdhsa_kernarg_size 96
  .amdhsa_user_sgpr_count 2
  .amdhsa_user_sgpr_kernarg_segment_ptr 1
  .amdhsa_system_sgpr_workgroup_id_x 1
.end_amdhsa_kernel
.p2align 6
.amdhsa_kernel k2_kernel
  .amdhsa_next_free_vgpr 232
  .amdhsa_next_free_sgpr 96
  .amdhsa_accum_offset 232
  .amdhsa_group_segment_fixed_size 0
  .amdhsa_kernarg_size 96
  .amdhsa_user_sgpr_count 2
  .amdhsa_user_sgpr_kernarg_segment_ptr 1
  .amdhsa_system_sgpr_workgroup_id_x 1
.end_amdhsa_kernel
.p2align 6
.amdhsa_kernel k3_kernel
  .amdhsa_next_free_vgpr 162
  .amdhsa_next_free_sgpr 96
  .amdhsa_accum_offset 164
  .amdhsa_group_segment_fixed_size 0
  .amdhsa_kernarg_size 96
  .amdhsa_user_sgpr_count 2
  .amdhsa_user_sgpr_kernarg_segment_ptr 1
  .amdhsa_system_sgpr_workgroup_id_x 1
.end_amdhsa_kernel
```
